```python
import torch

def _softmax(x, axis=-1):
    return torch.softmax(x, dim=axis)

def _gelu(x):
    return torch.nn.functional.gelu(x, approximate='tanh')

def _silu(x):
    return torch.nn.functional.silu(x)

def _sigmoid(x):
    return torch.sigmoid(x)

def _layernorm(x, axis=-1, eps=1e-05):
    m = x.mean(dim=axis, keepdim=True)
    v = x.var(dim=axis, keepdim=True, unbiased=False)
    return (x - m) / torch.sqrt(v + eps)

def _scatter_add(tgt, idx, src, axis=0):
    return tgt.clone().index_add_(axis, idx, src)

def _segment_sum(src, seg, n):
    out = torch.zeros((n,) + src.shape[1:], dtype=src.dtype)
    return out.index_add_(0, seg, src)

def _pad(x, pw):
    flat = tuple((v for pair in reversed(pw) for v in pair))
    return torch.nn.functional.pad(x, flat)
kernel_name = 'standalone__mixer_gmlp__prompt'

def setup_inputs():

    _w = lambda a: (lambda t: t.to(torch.bfloat16) if t.is_floating_point() else t)(torch.as_tensor(a))
    B, S, D, F = (1, 2048, 448, 1792)
    Fh = F // 2
    return {'x': _w((lambda *s: torch.randn(*s, dtype=torch.bfloat16) * 0.05)(B, S, D)), 'w_in': _w((lambda *s: torch.randn(*s, dtype=torch.bfloat16) * 0.4)(D, 2 * Fh)), 'w_sp': _w(0.01 * (lambda *s: torch.randn(*s, dtype=torch.bfloat16) * 0.4)(S, S)), 'b_sp': _w(1.0 + 0.01 * (lambda *s: torch.randn(*s, dtype=torch.bfloat16) * 0.05)(S)), 'w_out': _w((lambda *s: torch.randn(*s, dtype=torch.bfloat16) * 0.05)(Fh, D))}

def reference(x, w_in, w_sp, b_sp, w_out):
    B, S, D = x.shape
    F = w_in.shape[-1]
    Fh = F // 2
    z = _gelu(torch.einsum('bsd,df->bsf', x, w_in))
    z1 = z[..., :Fh].clone()
    z2 = _layernorm(z[..., Fh:], axis=-1)
    g = torch.einsum('ts,bsf->btf', w_sp, z2) + b_sp[None, :, None]
    return torch.einsum('bsf,fd->bsd', z1 * g, w_out)
```

```asm
; @launch kernel=k1_kernel grid=(256,1,1) block=(768,1,1) lds=147456
; @launch kernel=k3_kernel grid=(256,1,1) block=(512,1,1) lds=157696
; @launch kernel=k4_kernel grid=(224,1,1) block=(512,1,1) lds=163840
.amdgcn_target "amdgcn-amd-amdhsa--gfx950"
.text
.globl k1_kernel
.p2align 8
.type k1_kernel,@function
k1_kernel:
    s_cmp_ge_u32 s2, 256
    s_cbranch_scc1 k1_kernel_done
    s_load_dwordx16 s[16:31], s[0:1], 0
    v_lshrrev_b32 v1, 6, v0
    v_and_b32 v0, 63, v0
    v_readfirstlane_b32 s8, v1
    v_and_b32 v1, 15, v0
    v_lshrrev_b32 v2, 4, v0
    s_cmp_ge_u32 s2, 224
    s_cbranch_scc1 k1_pf
    s_and_b32 s3, s2, 7
    s_lshr_b32 s4, s2, 3
    s_lshl_b32 s5, s3, 2
    s_and_b32 s6, s4, 3
    s_add_u32 s5, s5, s6
    s_lshr_b32 s6, s4, 2
    s_cmp_ge_u32 s8, 8
    s_cbranch_scc1 k1_loader
    s_and_b32 s9, s8, 3
    s_lshr_b32 s10, s8, 2

    s_lshl_b32 s12, s9, 11
    v_lshrrev_b32 v9, 1, v1
    v_xor_b32 v9, v9, v2
    v_lshlrev_b32 v10, 7, v1
    v_add_u32 v10, s12, v10
    v_lshl_add_u32 v12, v9, 4, v10
    v_xor_b32 v13, 64, v12
    v_lshrrev_b32 v9, 2, v1
    v_and_b32 v10, 1, v2
    v_lshl_add_u32 v10, v10, 2, v9
    v_lshl_add_u32 v9, v2, 3, v9
    v_lshlrev_b32 v9, 8, v9
    v_and_b32 v11, 3, v1
    v_lshl_add_u32 v9, v11, 3, v9
    v_add_u32 v9, 8192, v9
    s_lshl_b32 s12, s10, 2
    s_add_u32 s13, s12, 0
    v_xor_b32 v11, s13, v10
    v_lshl_add_u32 v16, v11, 5, v9
    s_add_u32 s13, s12, 1
    v_xor_b32 v11, s13, v10
    v_lshl_add_u32 v17, v11, 5, v9
    s_add_u32 s13, s12, 2
    v_xor_b32 v11, s13, v10
    v_lshl_add_u32 v18, v11, 5, v9
    s_add_u32 s13, s12, 3
    v_xor_b32 v11, s13, v10
    v_lshl_add_u32 v19, v11, 5, v9
    s_lshl_b32 s12, s5, 2
    s_add_u32 s12, s12, s9
    s_mul_i32 s12, s12, 56
    s_lshl_b32 s13, s6, 3
    s_add_u32 s12, s12, s13
    s_lshl_b32 s13, s10, 2
    s_add_u32 s12, s12, s13
    s_lshl_b32 s12, s12, 9

    v_lshl_add_u32 v3, v0, 3, s12
    v_mov_b32 v4, 0xc0135761
    v_mov_b32 v5, 0xc0135761
    s_mov_b32 s48, 0xbdd2d3e8
    s_mov_b32 s49, 0xbdd2d3e8
    v_mov_b32 v64, 0
    v_mov_b32 v65, 0
    v_mov_b32 v66, 0
    v_mov_b32 v67, 0
    v_mov_b32 v68, 0
    v_mov_b32 v69, 0
    v_mov_b32 v70, 0
    v_mov_b32 v71, 0
    v_mov_b32 v72, 0
    v_mov_b32 v73, 0
    v_mov_b32 v74, 0
    v_mov_b32 v75, 0
    v_mov_b32 v76, 0
    v_mov_b32 v77, 0
    v_mov_b32 v78, 0
    v_mov_b32 v79, 0
    v_mov_b32 v80, 0
    v_mov_b32 v81, 0
    v_mov_b32 v82, 0
    v_mov_b32 v83, 0
    v_mov_b32 v84, 0
    v_mov_b32 v85, 0
    v_mov_b32 v86, 0
    v_mov_b32 v87, 0
    v_mov_b32 v88, 0
    v_mov_b32 v89, 0
    v_mov_b32 v90, 0
    v_mov_b32 v91, 0
    v_mov_b32 v92, 0
    v_mov_b32 v93, 0
    v_mov_b32 v94, 0
    v_mov_b32 v95, 0
    s_waitcnt lgkmcnt(0)
    s_mov_b32 s40, s30
    s_and_b32 s41, s31, 0xffff
    s_mov_b32 s42, 0x380000
    s_mov_b32 s43, 0x00020000
    s_add_u32 s44, s30, 0x1800000
    s_addc_u32 s45, s31, 0
    s_and_b32 s45, s45, 0xffff
    s_mov_b32 s46, 0x40000
    s_mov_b32 s47, 0x00020000
    s_mov_b32 s56, s28
    s_and_b32 s57, s29, 0xffff
    s_mov_b32 s58, 0x100
    s_mov_b32 s59, 0x00020000
    s_mov_b32 s90, 0
    v_mov_b32 v14, v12
    v_mov_b32 v15, v13
    v_mov_b32 v20, v16
    v_mov_b32 v21, v17
    v_mov_b32 v22, v18
    v_mov_b32 v23, v19
    s_barrier
    ds_read_b128 v[24:27], v14
    ds_read_b64_tr_b16 v[32:33], v20 offset:0
    ds_read_b64_tr_b16 v[34:35], v20 offset:1024
    ds_read_b64_tr_b16 v[36:37], v21 offset:0
    ds_read_b64_tr_b16 v[38:39], v21 offset:1024
    ds_read_b64_tr_b16 v[40:41], v22 offset:0
    ds_read_b64_tr_b16 v[42:43], v22 offset:1024
    ds_read_b64_tr_b16 v[44:45], v23 offset:0
    ds_read_b64_tr_b16 v[46:47], v23 offset:1024
    ds_read_b128 v[28:31], v15
    ds_read_b64_tr_b16 v[48:49], v20 offset:8192
    ds_read_b64_tr_b16 v[50:51], v20 offset:9216
    ds_read_b64_tr_b16 v[52:53], v21 offset:8192
    ds_read_b64_tr_b16 v[54:55], v21 offset:9216
    ds_read_b64_tr_b16 v[56:57], v22 offset:8192
    ds_read_b64_tr_b16 v[58:59], v22 offset:9216
    ds_read_b64_tr_b16 v[60:61], v23 offset:8192
    ds_read_b64_tr_b16 v[62:63], v23 offset:9216
    s_waitcnt lgkmcnt(9)
    v_mfma_f32_16x16x32_bf16 v[64:67], v[24:27], v[32:35], v[64:67]
    v_mfma_f32_16x16x32_bf16 v[68:71], v[24:27], v[36:39], v[68:71]
    v_mfma_f32_16x16x32_bf16 v[72:75], v[24:27], v[40:43], v[72:75]
    v_mfma_f32_16x16x32_bf16 v[76:79], v[24:27], v[44:47], v[76:79]
    s_waitcnt lgkmcnt(0)
    s_movk_i32 s91, 6
cl1:
    s_add_u32 s90, s90, 24576
    s_cmp_ge_u32 s90, 147456
    s_cselect_b32 s90, 0, s90
    v_add_u32 v14, s90, v12
    v_add_u32 v15, s90, v13
    v_add_u32 v20, s90, v16
    v_add_u32 v21, s90, v17
    v_add_u32 v22, s90, v18
    v_add_u32 v23, s90, v19
    s_barrier
    ds_read_b128 v[24:27], v14
    ds_read_b64_tr_b16 v[32:33], v20 offset:0
    ds_read_b64_tr_b16 v[34:35], v20 offset:1024
    ds_read_b64_tr_b16 v[36:37], v21 offset:0
    ds_read_b64_tr_b16 v[38:39], v21 offset:1024
    ds_read_b64_tr_b16 v[40:41], v22 offset:0
    ds_read_b64_tr_b16 v[42:43], v22 offset:1024
    ds_read_b64_tr_b16 v[44:45], v23 offset:0
    ds_read_b64_tr_b16 v[46:47], v23 offset:1024
    v_mfma_f32_16x16x32_bf16 v[64:67], v[28:31], v[48:51], v[64:67]
    v_mfma_f32_16x16x32_bf16 v[68:71], v[28:31], v[52:55], v[68:71]
    v_mfma_f32_16x16x32_bf16 v[72:75], v[28:31], v[56:59], v[72:75]
    v_mfma_f32_16x16x32_bf16 v[76:79], v[28:31], v[60:63], v[76:79]
    ds_read_b128 v[28:31], v15
    ds_read_b64_tr_b16 v[48:49], v20 offset:8192
    ds_read_b64_tr_b16 v[50:51], v20 offset:9216
    ds_read_b64_tr_b16 v[52:53], v21 offset:8192
    ds_read_b64_tr_b16 v[54:55], v21 offset:9216
    ds_read_b64_tr_b16 v[56:57], v22 offset:8192
    ds_read_b64_tr_b16 v[58:59], v22 offset:9216
    ds_read_b64_tr_b16 v[60:61], v23 offset:8192
    ds_read_b64_tr_b16 v[62:63], v23 offset:9216
    s_waitcnt lgkmcnt(9)
    v_mfma_f32_16x16x32_bf16 v[64:67], v[24:27], v[32:35], v[64:67]
    v_mfma_f32_16x16x32_bf16 v[68:71], v[24:27], v[36:39], v[68:71]
    v_mfma_f32_16x16x32_bf16 v[72:75], v[24:27], v[40:43], v[72:75]
    v_mfma_f32_16x16x32_bf16 v[76:79], v[24:27], v[44:47], v[76:79]
    s_sub_u32 s91, s91, 1
    s_cmp_lg_u32 s91, 0
    s_waitcnt lgkmcnt(0)
    s_cbranch_scc1 cl1
    v_mfma_f32_16x16x32_bf16 v[64:67], v[28:31], v[48:51], v[64:67]
    v_mfma_f32_16x16x32_bf16 v[68:71], v[28:31], v[52:55], v[68:71]
    v_mfma_f32_16x16x32_bf16 v[72:75], v[28:31], v[56:59], v[72:75]
    v_mfma_f32_16x16x32_bf16 v[76:79], v[28:31], v[60:63], v[76:79]
    s_nop 7
    s_nop 7
    v_cvt_pk_bf16_f32 v100, v64, v65
    v_cvt_pk_bf16_f32 v101, v66, v67
    v_lshlrev_b32 v96, 16, v100
    v_and_b32 v97, 0xffff0000, v100
    v_lshlrev_b32 v98, 16, v101
    v_and_b32 v99, 0xffff0000, v101
    v_pk_mul_f32 v[100:101], v[96:97], v[96:97]
    v_pk_mul_f32 v[102:103], v[98:99], v[98:99]
    v_pk_fma_f32 v[100:101], v[100:101], s[48:49], v[4:5]
    v_pk_fma_f32 v[102:103], v[102:103], s[48:49], v[4:5]
    v_pk_mul_f32 v[100:101], v[100:101], v[96:97]
    v_pk_mul_f32 v[102:103], v[102:103], v[98:99]
    v_exp_f32 v100, v100
    v_exp_f32 v101, v101
    v_exp_f32 v102, v102
    v_exp_f32 v103, v103
    s_nop 0
    v_pk_add_f32 v[100:101], v[100:101], 1.0 op_sel_hi:[1,0]
    v_pk_add_f32 v[102:103], v[102:103], 1.0 op_sel_hi:[1,0]
    v_rcp_f32 v100, v100
    v_rcp_f32 v101, v101
    v_rcp_f32 v102, v102
    v_rcp_f32 v103, v103
    s_nop 0
    v_pk_mul_f32 v[100:101], v[100:101], v[96:97]
    v_pk_mul_f32 v[102:103], v[102:103], v[98:99]
    v_cvt_pk_bf16_f32 v104, v100, v101
    v_cvt_pk_bf16_f32 v105, v102, v103
    v_lshlrev_b32 v64, 16, v104
    v_and_b32 v65, 0xffff0000, v104
    v_lshlrev_b32 v66, 16, v105
    v_and_b32 v67, 0xffff0000, v105
    v_cvt_pk_bf16_f32 v100, v68, v69
    v_cvt_pk_bf16_f32 v101, v70, v71
    v_lshlrev_b32 v96, 16, v100
    v_and_b32 v97, 0xffff0000, v100
    v_lshlrev_b32 v98, 16, v101
    v_and_b32 v99, 0xffff0000, v101
    v_pk_mul_f32 v[100:101], v[96:97], v[96:97]
    v_pk_mul_f32 v[102:103], v[98:99], v[98:99]
    v_pk_fma_f32 v[100:101], v[100:101], s[48:49], v[4:5]
    v_pk_fma_f32 v[102:103], v[102:103], s[48:49], v[4:5]
    v_pk_mul_f32 v[100:101], v[100:101], v[96:97]
    v_pk_mul_f32 v[102:103], v[102:103], v[98:99]
    v_exp_f32 v100, v100
    v_exp_f32 v101, v101
    v_exp_f32 v102, v102
    v_exp_f32 v103, v103
    s_nop 0
    v_pk_add_f32 v[100:101], v[100:101], 1.0 op_sel_hi:[1,0]
    v_pk_add_f32 v[102:103], v[102:103], 1.0 op_sel_hi:[1,0]
    v_rcp_f32 v100, v100
    v_rcp_f32 v101, v101
    v_rcp_f32 v102, v102
    v_rcp_f32 v103, v103
    s_nop 0
    v_pk_mul_f32 v[100:101], v[100:101], v[96:97]
    v_pk_mul_f32 v[102:103], v[102:103], v[98:99]
    v_cvt_pk_bf16_f32 v104, v100, v101
    v_cvt_pk_bf16_f32 v105, v102, v103
    v_lshlrev_b32 v68, 16, v104
    v_and_b32 v69, 0xffff0000, v104
    v_lshlrev_b32 v70, 16, v105
    v_and_b32 v71, 0xffff0000, v105
    v_cvt_pk_bf16_f32 v100, v72, v73
    v_cvt_pk_bf16_f32 v101, v74, v75
    v_lshlrev_b32 v96, 16, v100
    v_and_b32 v97, 0xffff0000, v100
    v_lshlrev_b32 v98, 16, v101
    v_and_b32 v99, 0xffff0000, v101
    v_pk_mul_f32 v[100:101], v[96:97], v[96:97]
    v_pk_mul_f32 v[102:103], v[98:99], v[98:99]
    v_pk_fma_f32 v[100:101], v[100:101], s[48:49], v[4:5]
    v_pk_fma_f32 v[102:103], v[102:103], s[48:49], v[4:5]
    v_pk_mul_f32 v[100:101], v[100:101], v[96:97]
    v_pk_mul_f32 v[102:103], v[102:103], v[98:99]
    v_exp_f32 v100, v100
    v_exp_f32 v101, v101
    v_exp_f32 v102, v102
    v_exp_f32 v103, v103
    s_nop 0
    v_pk_add_f32 v[100:101], v[100:101], 1.0 op_sel_hi:[1,0]
    v_pk_add_f32 v[102:103], v[102:103], 1.0 op_sel_hi:[1,0]
    v_rcp_f32 v100, v100
    v_rcp_f32 v101, v101
    v_rcp_f32 v102, v102
    v_rcp_f32 v103, v103
    s_nop 0
    v_pk_mul_f32 v[100:101], v[100:101], v[96:97]
    v_pk_mul_f32 v[102:103], v[102:103], v[98:99]
    v_cvt_pk_bf16_f32 v104, v100, v101
    v_cvt_pk_bf16_f32 v105, v102, v103
    v_lshlrev_b32 v72, 16, v104
    v_and_b32 v73, 0xffff0000, v104
    v_lshlrev_b32 v74, 16, v105
    v_and_b32 v75, 0xffff0000, v105
    v_cvt_pk_bf16_f32 v100, v76, v77
    v_cvt_pk_bf16_f32 v101, v78, v79
    v_lshlrev_b32 v96, 16, v100
    v_and_b32 v97, 0xffff0000, v100
    v_lshlrev_b32 v98, 16, v101
    v_and_b32 v99, 0xffff0000, v101
    v_pk_mul_f32 v[100:101], v[96:97], v[96:97]
    v_pk_mul_f32 v[102:103], v[98:99], v[98:99]
    v_pk_fma_f32 v[100:101], v[100:101], s[48:49], v[4:5]
    v_pk_fma_f32 v[102:103], v[102:103], s[48:49], v[4:5]
    v_pk_mul_f32 v[100:101], v[100:101], v[96:97]
    v_pk_mul_f32 v[102:103], v[102:103], v[98:99]
    v_exp_f32 v100, v100
    v_exp_f32 v101, v101
    v_exp_f32 v102, v102
    v_exp_f32 v103, v103
    s_nop 0
    v_pk_add_f32 v[100:101], v[100:101], 1.0 op_sel_hi:[1,0]
    v_pk_add_f32 v[102:103], v[102:103], 1.0 op_sel_hi:[1,0]
    v_rcp_f32 v100, v100
    v_rcp_f32 v101, v101
    v_rcp_f32 v102, v102
    v_rcp_f32 v103, v103
    s_nop 0
    v_pk_mul_f32 v[100:101], v[100:101], v[96:97]
    v_pk_mul_f32 v[102:103], v[102:103], v[98:99]
    v_cvt_pk_bf16_f32 v104, v100, v101
    v_cvt_pk_bf16_f32 v105, v102, v103
    v_lshlrev_b32 v76, 16, v104
    v_and_b32 v77, 0xffff0000, v104
    v_lshlrev_b32 v78, 16, v105
    v_and_b32 v79, 0xffff0000, v105
    v_pk_add_f32 v[96:97], v[64:65], v[68:69]
    v_pk_add_f32 v[6:7], v[72:73], v[76:77]
    v_pk_add_f32 v[96:97], v[96:97], v[6:7]
    v_pk_add_f32 v[98:99], v[66:67], v[70:71]
    v_pk_add_f32 v[6:7], v[74:75], v[78:79]
    v_pk_add_f32 v[98:99], v[98:99], v[6:7]
    s_nop 1
    v_add_f32_dpp v96, v96, v96 row_ror:8 row_mask:0xf bank_mask:0xf
    v_add_f32_dpp v97, v97, v97 row_ror:8 row_mask:0xf bank_mask:0xf
    v_add_f32_dpp v98, v98, v98 row_ror:8 row_mask:0xf bank_mask:0xf
    v_add_f32_dpp v99, v99, v99 row_ror:8 row_mask:0xf bank_mask:0xf
    s_nop 1
    v_add_f32_dpp v96, v96, v96 row_ror:4 row_mask:0xf bank_mask:0xf
    v_add_f32_dpp v97, v97, v97 row_ror:4 row_mask:0xf bank_mask:0xf
    v_add_f32_dpp v98, v98, v98 row_ror:4 row_mask:0xf bank_mask:0xf
    v_add_f32_dpp v99, v99, v99 row_ror:4 row_mask:0xf bank_mask:0xf
    s_nop 1
    v_add_f32_dpp v96, v96, v96 row_ror:2 row_mask:0xf bank_mask:0xf
    v_add_f32_dpp v97, v97, v97 row_ror:2 row_mask:0xf bank_mask:0xf
    v_add_f32_dpp v98, v98, v98 row_ror:2 row_mask:0xf bank_mask:0xf
    v_add_f32_dpp v99, v99, v99 row_ror:2 row_mask:0xf bank_mask:0xf
    s_nop 1
    v_add_f32_dpp v96, v96, v96 row_ror:1 row_mask:0xf bank_mask:0xf
    v_add_f32_dpp v97, v97, v97 row_ror:1 row_mask:0xf bank_mask:0xf
    v_add_f32_dpp v98, v98, v98 row_ror:1 row_mask:0xf bank_mask:0xf
    v_add_f32_dpp v99, v99, v99 row_ror:1 row_mask:0xf bank_mask:0xf
    s_mov_b32 s52, 0x3c800000
    v_mul_f32 v96, s52, v96
    v_mul_f32 v97, s52, v97
    v_mul_f32 v98, s52, v98
    v_mul_f32 v99, s52, v99
    v_pk_add_f32 v[6:7], v[64:65], v[96:97] neg_lo:[0,1] neg_hi:[0,1]
    v_pk_mul_f32 v[100:101], v[6:7], v[6:7]
    v_pk_add_f32 v[6:7], v[68:69], v[96:97] neg_lo:[0,1] neg_hi:[0,1]
    v_pk_fma_f32 v[100:101], v[6:7], v[6:7], v[100:101]
    v_pk_add_f32 v[6:7], v[72:73], v[96:97] neg_lo:[0,1] neg_hi:[0,1]
    v_pk_fma_f32 v[100:101], v[6:7], v[6:7], v[100:101]
    v_pk_add_f32 v[6:7], v[76:77], v[96:97] neg_lo:[0,1] neg_hi:[0,1]
    v_pk_fma_f32 v[100:101], v[6:7], v[6:7], v[100:101]
    v_pk_add_f32 v[6:7], v[66:67], v[98:99] neg_lo:[0,1] neg_hi:[0,1]
    v_pk_mul_f32 v[102:103], v[6:7], v[6:7]
    v_pk_add_f32 v[6:7], v[70:71], v[98:99] neg_lo:[0,1] neg_hi:[0,1]
    v_pk_fma_f32 v[102:103], v[6:7], v[6:7], v[102:103]
    v_pk_add_f32 v[6:7], v[74:75], v[98:99] neg_lo:[0,1] neg_hi:[0,1]
    v_pk_fma_f32 v[102:103], v[6:7], v[6:7], v[102:103]
    v_pk_add_f32 v[6:7], v[78:79], v[98:99] neg_lo:[0,1] neg_hi:[0,1]
    v_pk_fma_f32 v[102:103], v[6:7], v[6:7], v[102:103]
    s_nop 1
    v_add_f32_dpp v100, v100, v100 row_ror:8 row_mask:0xf bank_mask:0xf
    v_add_f32_dpp v101, v101, v101 row_ror:8 row_mask:0xf bank_mask:0xf
    v_add_f32_dpp v102, v102, v102 row_ror:8 row_mask:0xf bank_mask:0xf
    v_add_f32_dpp v103, v103, v103 row_ror:8 row_mask:0xf bank_mask:0xf
    s_nop 1
    v_add_f32_dpp v100, v100, v100 row_ror:4 row_mask:0xf bank_mask:0xf
    v_add_f32_dpp v101, v101, v101 row_ror:4 row_mask:0xf bank_mask:0xf
    v_add_f32_dpp v102, v102, v102 row_ror:4 row_mask:0xf bank_mask:0xf
    v_add_f32_dpp v103, v103, v103 row_ror:4 row_mask:0xf bank_mask:0xf
    s_nop 1
    v_add_f32_dpp v100, v100, v100 row_ror:2 row_mask:0xf bank_mask:0xf
    v_add_f32_dpp v101, v101, v101 row_ror:2 row_mask:0xf bank_mask:0xf
    v_add_f32_dpp v102, v102, v102 row_ror:2 row_mask:0xf bank_mask:0xf
    v_add_f32_dpp v103, v103, v103 row_ror:2 row_mask:0xf bank_mask:0xf
    s_nop 1
    v_add_f32_dpp v100, v100, v100 row_ror:1 row_mask:0xf bank_mask:0xf
    v_add_f32_dpp v101, v101, v101 row_ror:1 row_mask:0xf bank_mask:0xf
    v_add_f32_dpp v102, v102, v102 row_ror:1 row_mask:0xf bank_mask:0xf
    v_add_f32_dpp v103, v103, v103 row_ror:1 row_mask:0xf bank_mask:0xf
    v_mov_b32 v104, v96
    v_mov_b32 v105, v100
    v_mov_b32 v106, v97
    v_mov_b32 v107, v101
    v_mov_b32 v108, v98
    v_mov_b32 v109, v102
    v_mov_b32 v110, v99
    v_mov_b32 v111, v103
    s_lshl_b32 s52, s5, 6
    s_lshl_b32 s53, s9, 4
    s_add_u32 s52, s52, s53
    s_lshl_b32 s52, s52, 7
    s_lshl_b32 s53, s6, 1
    s_add_u32 s53, s53, s10
    s_lshl_b32 s53, s53, 3
    s_add_u32 s53, s53, s52
    s_lshl_b32 s55, s5, 3

    v_lshlrev_b32 v8, 9, v2
    v_add_u32 v6, s53, v8
    v_lshl_add_u32 v8, v1, 3, v8
    v_add_u32 v8, s52, v8
    v_cmp_eq_u32 vcc, 0, v1
    v_mov_b32 v9, s55
    v_mov_b32 v10, 1
    s_mov_b64 exec, vcc
    buffer_store_dwordx2 v[104:105], v6, s[44:47], 0 offen offset:0 sc1
    buffer_store_dwordx2 v[106:107], v6, s[44:47], 0 offen offset:128 sc1
    buffer_store_dwordx2 v[108:109], v6, s[44:47], 0 offen offset:256 sc1
    buffer_store_dwordx2 v[110:111], v6, s[44:47], 0 offen offset:384 sc1
    s_mov_b64 exec, -1
    s_waitcnt vmcnt(0)
    s_add_u32 s90, s90, 24576
    s_cmp_ge_u32 s90, 147456
    s_cselect_b32 s90, 0, s90
    v_add_u32 v14, s90, v12
    v_add_u32 v15, s90, v13
    v_add_u32 v20, s90, v16
    v_add_u32 v21, s90, v17
    v_add_u32 v22, s90, v18
    v_add_u32 v23, s90, v19
    s_barrier
    s_cmp_lg_u32 s8, 0
    s_cbranch_scc1 k1_nosig
    s_mov_b64 exec, 1
    buffer_atomic_add v10, v9, s[56:59], 0 offen
    s_mov_b64 exec, -1
k1_nosig:
    ds_read_b128 v[24:27], v14
    ds_read_b64_tr_b16 v[32:33], v20 offset:0
    ds_read_b64_tr_b16 v[34:35], v20 offset:1024
    ds_read_b64_tr_b16 v[36:37], v21 offset:0
    ds_read_b64_tr_b16 v[38:39], v21 offset:1024
    ds_read_b64_tr_b16 v[40:41], v22 offset:0
    ds_read_b64_tr_b16 v[42:43], v22 offset:1024
    ds_read_b64_tr_b16 v[44:45], v23 offset:0
    ds_read_b64_tr_b16 v[46:47], v23 offset:1024
    ds_read_b128 v[28:31], v15
    ds_read_b64_tr_b16 v[48:49], v20 offset:8192
    ds_read_b64_tr_b16 v[50:51], v20 offset:9216
    ds_read_b64_tr_b16 v[52:53], v21 offset:8192
    ds_read_b64_tr_b16 v[54:55], v21 offset:9216
    ds_read_b64_tr_b16 v[56:57], v22 offset:8192
    ds_read_b64_tr_b16 v[58:59], v22 offset:9216
    ds_read_b64_tr_b16 v[60:61], v23 offset:8192
    ds_read_b64_tr_b16 v[62:63], v23 offset:9216
    s_waitcnt lgkmcnt(9)
    v_mfma_f32_16x16x32_bf16 v[80:83], v[32:35], v[24:27], v[80:83]
    v_mfma_f32_16x16x32_bf16 v[84:87], v[36:39], v[24:27], v[84:87]
    v_mfma_f32_16x16x32_bf16 v[88:91], v[40:43], v[24:27], v[88:91]
    v_mfma_f32_16x16x32_bf16 v[92:95], v[44:47], v[24:27], v[92:95]
    s_waitcnt lgkmcnt(0)
    s_movk_i32 s91, 6
cl2:
    s_add_u32 s90, s90, 24576
    s_cmp_ge_u32 s90, 147456
    s_cselect_b32 s90, 0, s90
    v_add_u32 v14, s90, v12
    v_add_u32 v15, s90, v13
    v_add_u32 v20, s90, v16
    v_add_u32 v21, s90, v17
    v_add_u32 v22, s90, v18
    v_add_u32 v23, s90, v19
    s_barrier
    ds_read_b128 v[24:27], v14
    ds_read_b64_tr_b16 v[32:33], v20 offset:0
    ds_read_b64_tr_b16 v[34:35], v20 offset:1024
    ds_read_b64_tr_b16 v[36:37], v21 offset:0
    ds_read_b64_tr_b16 v[38:39], v21 offset:1024
    ds_read_b64_tr_b16 v[40:41], v22 offset:0
    ds_read_b64_tr_b16 v[42:43], v22 offset:1024
    ds_read_b64_tr_b16 v[44:45], v23 offset:0
    ds_read_b64_tr_b16 v[46:47], v23 offset:1024
    v_mfma_f32_16x16x32_bf16 v[80:83], v[48:51], v[28:31], v[80:83]
    v_mfma_f32_16x16x32_bf16 v[84:87], v[52:55], v[28:31], v[84:87]
    v_mfma_f32_16x16x32_bf16 v[88:91], v[56:59], v[28:31], v[88:91]
    v_mfma_f32_16x16x32_bf16 v[92:95], v[60:63], v[28:31], v[92:95]
    ds_read_b128 v[28:31], v15
    ds_read_b64_tr_b16 v[48:49], v20 offset:8192
    ds_read_b64_tr_b16 v[50:51], v20 offset:9216
    ds_read_b64_tr_b16 v[52:53], v21 offset:8192
    ds_read_b64_tr_b16 v[54:55], v21 offset:9216
    ds_read_b64_tr_b16 v[56:57], v22 offset:8192
    ds_read_b64_tr_b16 v[58:59], v22 offset:9216
    ds_read_b64_tr_b16 v[60:61], v23 offset:8192
    ds_read_b64_tr_b16 v[62:63], v23 offset:9216
    s_waitcnt lgkmcnt(9)
    v_mfma_f32_16x16x32_bf16 v[80:83], v[32:35], v[24:27], v[80:83]
    v_mfma_f32_16x16x32_bf16 v[84:87], v[36:39], v[24:27], v[84:87]
    v_mfma_f32_16x16x32_bf16 v[88:91], v[40:43], v[24:27], v[88:91]
    v_mfma_f32_16x16x32_bf16 v[92:95], v[44:47], v[24:27], v[92:95]
    s_sub_u32 s91, s91, 1
    s_cmp_lg_u32 s91, 0
    s_waitcnt lgkmcnt(0)
    s_cbranch_scc1 cl2
    v_mfma_f32_16x16x32_bf16 v[80:83], v[48:51], v[28:31], v[80:83]
    v_mfma_f32_16x16x32_bf16 v[84:87], v[52:55], v[28:31], v[84:87]
    v_mfma_f32_16x16x32_bf16 v[88:91], v[56:59], v[28:31], v[88:91]
    v_mfma_f32_16x16x32_bf16 v[92:95], v[60:63], v[28:31], v[92:95]
    s_nop 7
    s_nop 7
    v_cvt_pk_bf16_f32 v100, v80, v81
    v_cvt_pk_bf16_f32 v101, v82, v83
    v_lshlrev_b32 v96, 16, v100
    v_and_b32 v97, 0xffff0000, v100
    v_lshlrev_b32 v98, 16, v101
    v_and_b32 v99, 0xffff0000, v101
    v_pk_mul_f32 v[100:101], v[96:97], v[96:97]
    v_pk_mul_f32 v[102:103], v[98:99], v[98:99]
    v_pk_fma_f32 v[100:101], v[100:101], s[48:49], v[4:5]
    v_pk_fma_f32 v[102:103], v[102:103], s[48:49], v[4:5]
    v_pk_mul_f32 v[100:101], v[100:101], v[96:97]
    v_pk_mul_f32 v[102:103], v[102:103], v[98:99]
    v_exp_f32 v100, v100
    v_exp_f32 v101, v101
    v_exp_f32 v102, v102
    v_exp_f32 v103, v103
    s_nop 0
    v_pk_add_f32 v[100:101], v[100:101], 1.0 op_sel_hi:[1,0]
    v_pk_add_f32 v[102:103], v[102:103], 1.0 op_sel_hi:[1,0]
    v_rcp_f32 v100, v100
    v_rcp_f32 v101, v101
    v_rcp_f32 v102, v102
    v_rcp_f32 v103, v103
    s_nop 0
    v_pk_mul_f32 v[100:101], v[100:101], v[96:97]
    v_pk_mul_f32 v[102:103], v[102:103], v[98:99]
    v_cvt_pk_bf16_f32 v104, v100, v101
    v_cvt_pk_bf16_f32 v105, v102, v103
    buffer_store_dwordx2 v[104:105], v3, s[40:43], 0 offen offset:0
    v_cvt_pk_bf16_f32 v100, v84, v85
    v_cvt_pk_bf16_f32 v101, v86, v87
    v_lshlrev_b32 v96, 16, v100
    v_and_b32 v97, 0xffff0000, v100
    v_lshlrev_b32 v98, 16, v101
    v_and_b32 v99, 0xffff0000, v101
    v_pk_mul_f32 v[100:101], v[96:97], v[96:97]
    v_pk_mul_f32 v[102:103], v[98:99], v[98:99]
    v_pk_fma_f32 v[100:101], v[100:101], s[48:49], v[4:5]
    v_pk_fma_f32 v[102:103], v[102:103], s[48:49], v[4:5]
    v_pk_mul_f32 v[100:101], v[100:101], v[96:97]
    v_pk_mul_f32 v[102:103], v[102:103], v[98:99]
    v_exp_f32 v100, v100
    v_exp_f32 v101, v101
    v_exp_f32 v102, v102
    v_exp_f32 v103, v103
    s_nop 0
    v_pk_add_f32 v[100:101], v[100:101], 1.0 op_sel_hi:[1,0]
    v_pk_add_f32 v[102:103], v[102:103], 1.0 op_sel_hi:[1,0]
    v_rcp_f32 v100, v100
    v_rcp_f32 v101, v101
    v_rcp_f32 v102, v102
    v_rcp_f32 v103, v103
    s_nop 0
    v_pk_mul_f32 v[100:101], v[100:101], v[96:97]
    v_pk_mul_f32 v[102:103], v[102:103], v[98:99]
    v_cvt_pk_bf16_f32 v106, v100, v101
    v_cvt_pk_bf16_f32 v107, v102, v103
    buffer_store_dwordx2 v[106:107], v3, s[40:43], 0 offen offset:512
    v_cvt_pk_bf16_f32 v100, v88, v89
    v_cvt_pk_bf16_f32 v101, v90, v91
    v_lshlrev_b32 v96, 16, v100
    v_and_b32 v97, 0xffff0000, v100
    v_lshlrev_b32 v98, 16, v101
    v_and_b32 v99, 0xffff0000, v101
    v_pk_mul_f32 v[100:101], v[96:97], v[96:97]
    v_pk_mul_f32 v[102:103], v[98:99], v[98:99]
    v_pk_fma_f32 v[100:101], v[100:101], s[48:49], v[4:5]
    v_pk_fma_f32 v[102:103], v[102:103], s[48:49], v[4:5]
    v_pk_mul_f32 v[100:101], v[100:101], v[96:97]
    v_pk_mul_f32 v[102:103], v[102:103], v[98:99]
    v_exp_f32 v100, v100
    v_exp_f32 v101, v101
    v_exp_f32 v102, v102
    v_exp_f32 v103, v103
    s_nop 0
    v_pk_add_f32 v[100:101], v[100:101], 1.0 op_sel_hi:[1,0]
    v_pk_add_f32 v[102:103], v[102:103], 1.0 op_sel_hi:[1,0]
    v_rcp_f32 v100, v100
    v_rcp_f32 v101, v101
    v_rcp_f32 v102, v102
    v_rcp_f32 v103, v103
    s_nop 0
    v_pk_mul_f32 v[100:101], v[100:101], v[96:97]
    v_pk_mul_f32 v[102:103], v[102:103], v[98:99]
    v_cvt_pk_bf16_f32 v104, v100, v101
    v_cvt_pk_bf16_f32 v105, v102, v103
    buffer_store_dwordx2 v[104:105], v3, s[40:43], 0 offen offset:1024
    v_cvt_pk_bf16_f32 v100, v92, v93
    v_cvt_pk_bf16_f32 v101, v94, v95
    v_lshlrev_b32 v96, 16, v100
    v_and_b32 v97, 0xffff0000, v100
    v_lshlrev_b32 v98, 16, v101
    v_and_b32 v99, 0xffff0000, v101
    v_pk_mul_f32 v[100:101], v[96:97], v[96:97]
    v_pk_mul_f32 v[102:103], v[98:99], v[98:99]
    v_pk_fma_f32 v[100:101], v[100:101], s[48:49], v[4:5]
    v_pk_fma_f32 v[102:103], v[102:103], s[48:49], v[4:5]
    v_pk_mul_f32 v[100:101], v[100:101], v[96:97]
    v_pk_mul_f32 v[102:103], v[102:103], v[98:99]
    v_exp_f32 v100, v100
    v_exp_f32 v101, v101
    v_exp_f32 v102, v102
    v_exp_f32 v103, v103
    s_nop 0
    v_pk_add_f32 v[100:101], v[100:101], 1.0 op_sel_hi:[1,0]
    v_pk_add_f32 v[102:103], v[102:103], 1.0 op_sel_hi:[1,0]
    v_rcp_f32 v100, v100
    v_rcp_f32 v101, v101
    v_rcp_f32 v102, v102
    v_rcp_f32 v103, v103
    s_nop 0
    v_pk_mul_f32 v[100:101], v[100:101], v[96:97]
    v_pk_mul_f32 v[102:103], v[102:103], v[98:99]
    v_cvt_pk_bf16_f32 v106, v100, v101
    v_cvt_pk_bf16_f32 v107, v102, v103
    buffer_store_dwordx2 v[106:107], v3, s[40:43], 0 offen offset:1536
    s_cmp_lg_u32 s8, 0
    s_cbranch_scc1 k1_go
    s_mov_b64 exec, 1
    s_mov_b32 s54, 0
k1_poll:
    buffer_load_dword v6, v9, s[56:59], 0 offen sc1
    s_waitcnt vmcnt(0)
    v_readfirstlane_b32 s55, v6
    s_add_u32 s54, s54, 1
    s_cmp_ge_u32 s55, 7
    s_cbranch_scc1 k1_pdone
    s_sleep 1
    s_cmp_lt_u32 s54, 0x400000
    s_cbranch_scc1 k1_poll
k1_pdone:
    s_mov_b64 exec, -1
k1_go:
    s_barrier
    buffer_load_dwordx2 v[24:25], v8, s[44:47], 0 offen offset:0 sc1
    buffer_load_dwordx2 v[26:27], v8, s[44:47], 0 offen offset:128 sc1
    buffer_load_dwordx2 v[28:29], v8, s[44:47], 0 offen offset:256 sc1
    buffer_load_dwordx2 v[30:31], v8, s[44:47], 0 offen offset:384 sc1
    s_lshl_b32 s52, s6, 3
    s_lshl_b32 s53, s10, 2
    s_add_u32 s52, s52, s53
    s_lshl_b32 s52, s52, 16
    s_lshl_b32 s53, s5, 1
    s_lshr_b32 s54, s9, 1
    s_add_u32 s53, s53, s54
    s_lshl_b32 s53, s53, 10
    s_add_u32 s52, s52, s53
    s_and_b32 s53, s9, 1
    s_lshl_b32 s53, s53, 9
    s_add_u32 s52, s52, s53

    v_lshrrev_b32 v11, 1, v2
    v_lshl_add_u32 v11, v11, 4, v1
    v_lshlrev_b32 v11, 4, v11
    v_and_b32 v6, 1, v2
    v_lshl_add_u32 v11, v6, 3, v11
    v_add_u32 v11, s52, v11
    s_add_u32 s40, s30, 0x800000
    s_addc_u32 s41, s31, 0
    s_and_b32 s41, s41, 0xffff
    s_mov_b32 s42, 0x380000
    s_mov_b32 s43, 0x00020000
    v_cmp_gt_u32 vcc, 14, v1
    s_mov_b32 s52, 0x3d924925
    s_mov_b32 s53, 0x42800000
    s_mov_b32 s54, 0x3a924925
    s_waitcnt vmcnt(0)
    v_cndmask_b32 v24, 0, v24, vcc
    v_cndmask_b32 v25, 0, v25, vcc
    v_mov_b32 v32, v24
    v_cndmask_b32 v26, 0, v26, vcc
    v_cndmask_b32 v27, 0, v27, vcc
    v_mov_b32 v33, v26
    v_cndmask_b32 v28, 0, v28, vcc
    v_cndmask_b32 v29, 0, v29, vcc
    v_mov_b32 v34, v28
    v_cndmask_b32 v30, 0, v30, vcc
    v_cndmask_b32 v31, 0, v31, vcc
    v_mov_b32 v35, v30
    s_nop 1
    v_add_f32_dpp v32, v32, v32 row_ror:8 row_mask:0xf bank_mask:0xf
    v_add_f32_dpp v33, v33, v33 row_ror:8 row_mask:0xf bank_mask:0xf
    v_add_f32_dpp v34, v34, v34 row_ror:8 row_mask:0xf bank_mask:0xf
    v_add_f32_dpp v35, v35, v35 row_ror:8 row_mask:0xf bank_mask:0xf
    s_nop 1
    v_add_f32_dpp v32, v32, v32 row_ror:4 row_mask:0xf bank_mask:0xf
    v_add_f32_dpp v33, v33, v33 row_ror:4 row_mask:0xf bank_mask:0xf
    v_add_f32_dpp v34, v34, v34 row_ror:4 row_mask:0xf bank_mask:0xf
    v_add_f32_dpp v35, v35, v35 row_ror:4 row_mask:0xf bank_mask:0xf
    s_nop 1
    v_add_f32_dpp v32, v32, v32 row_ror:2 row_mask:0xf bank_mask:0xf
    v_add_f32_dpp v33, v33, v33 row_ror:2 row_mask:0xf bank_mask:0xf
    v_add_f32_dpp v34, v34, v34 row_ror:2 row_mask:0xf bank_mask:0xf
    v_add_f32_dpp v35, v35, v35 row_ror:2 row_mask:0xf bank_mask:0xf
    s_nop 1
    v_add_f32_dpp v32, v32, v32 row_ror:1 row_mask:0xf bank_mask:0xf
    v_add_f32_dpp v33, v33, v33 row_ror:1 row_mask:0xf bank_mask:0xf
    v_add_f32_dpp v34, v34, v34 row_ror:1 row_mask:0xf bank_mask:0xf
    v_add_f32_dpp v35, v35, v35 row_ror:1 row_mask:0xf bank_mask:0xf
    v_mul_f32 v32, s52, v32
    v_sub_f32 v6, v24, v32
    v_mul_f32 v6, v6, v6
    v_fma_f32 v36, v6, s53, v25
    v_cndmask_b32 v36, 0, v36, vcc
    v_mul_f32 v33, s52, v33
    v_sub_f32 v6, v26, v33
    v_mul_f32 v6, v6, v6
    v_fma_f32 v37, v6, s53, v27
    v_cndmask_b32 v37, 0, v37, vcc
    v_mul_f32 v34, s52, v34
    v_sub_f32 v6, v28, v34
    v_mul_f32 v6, v6, v6
    v_fma_f32 v38, v6, s53, v29
    v_cndmask_b32 v38, 0, v38, vcc
    v_mul_f32 v35, s52, v35
    v_sub_f32 v6, v30, v35
    v_mul_f32 v6, v6, v6
    v_fma_f32 v39, v6, s53, v31
    v_cndmask_b32 v39, 0, v39, vcc
    s_nop 1
    v_add_f32_dpp v36, v36, v36 row_ror:8 row_mask:0xf bank_mask:0xf
    v_add_f32_dpp v37, v37, v37 row_ror:8 row_mask:0xf bank_mask:0xf
    v_add_f32_dpp v38, v38, v38 row_ror:8 row_mask:0xf bank_mask:0xf
    v_add_f32_dpp v39, v39, v39 row_ror:8 row_mask:0xf bank_mask:0xf
    s_nop 1
    v_add_f32_dpp v36, v36, v36 row_ror:4 row_mask:0xf bank_mask:0xf
    v_add_f32_dpp v37, v37, v37 row_ror:4 row_mask:0xf bank_mask:0xf
    v_add_f32_dpp v38, v38, v38 row_ror:4 row_mask:0xf bank_mask:0xf
    v_add_f32_dpp v39, v39, v39 row_ror:4 row_mask:0xf bank_mask:0xf
    s_nop 1
    v_add_f32_dpp v36, v36, v36 row_ror:2 row_mask:0xf bank_mask:0xf
    v_add_f32_dpp v37, v37, v37 row_ror:2 row_mask:0xf bank_mask:0xf
    v_add_f32_dpp v38, v38, v38 row_ror:2 row_mask:0xf bank_mask:0xf
    v_add_f32_dpp v39, v39, v39 row_ror:2 row_mask:0xf bank_mask:0xf
    s_nop 1
    v_add_f32_dpp v36, v36, v36 row_ror:1 row_mask:0xf bank_mask:0xf
    v_add_f32_dpp v37, v37, v37 row_ror:1 row_mask:0xf bank_mask:0xf
    v_add_f32_dpp v38, v38, v38 row_ror:1 row_mask:0xf bank_mask:0xf
    v_add_f32_dpp v39, v39, v39 row_ror:1 row_mask:0xf bank_mask:0xf
    v_mul_f32 v36, s54, v36
    v_cvt_pk_bf16_f32 v32, v32, v32
    v_lshlrev_b32 v32, 16, v32
    v_cvt_pk_bf16_f32 v36, v36, v36
    v_lshlrev_b32 v36, 16, v36
    v_add_f32 v36, 0x3727c5ac, v36
    v_cvt_pk_bf16_f32 v36, v36, v36
    v_lshlrev_b32 v36, 16, v36
    v_sqrt_f32 v36, v36
    v_mul_f32 v37, s54, v37
    v_cvt_pk_bf16_f32 v33, v33, v33
    v_lshlrev_b32 v33, 16, v33
    v_cvt_pk_bf16_f32 v37, v37, v37
    v_lshlrev_b32 v37, 16, v37
    v_add_f32 v37, 0x3727c5ac, v37
    v_cvt_pk_bf16_f32 v37, v37, v37
    v_lshlrev_b32 v37, 16, v37
    v_sqrt_f32 v37, v37
    v_mul_f32 v38, s54, v38
    v_cvt_pk_bf16_f32 v34, v34, v34
    v_lshlrev_b32 v34, 16, v34
    v_cvt_pk_bf16_f32 v38, v38, v38
    v_lshlrev_b32 v38, 16, v38
    v_add_f32 v38, 0x3727c5ac, v38
    v_cvt_pk_bf16_f32 v38, v38, v38
    v_lshlrev_b32 v38, 16, v38
    v_sqrt_f32 v38, v38
    v_mul_f32 v39, s54, v39
    v_cvt_pk_bf16_f32 v35, v35, v35
    v_lshlrev_b32 v35, 16, v35
    v_cvt_pk_bf16_f32 v39, v39, v39
    v_lshlrev_b32 v39, 16, v39
    v_add_f32 v39, 0x3727c5ac, v39
    v_cvt_pk_bf16_f32 v39, v39, v39
    v_lshlrev_b32 v39, 16, v39
    v_sqrt_f32 v39, v39
    s_nop 0
    v_cvt_pk_bf16_f32 v36, v36, v36
    v_lshlrev_b32 v36, 16, v36
    v_rcp_f32 v40, v36
    v_cvt_pk_bf16_f32 v37, v37, v37
    v_lshlrev_b32 v37, 16, v37
    v_rcp_f32 v41, v37
    v_cvt_pk_bf16_f32 v38, v38, v38
    v_lshlrev_b32 v38, 16, v38
    v_rcp_f32 v42, v38
    v_cvt_pk_bf16_f32 v39, v39, v39
    v_lshlrev_b32 v39, 16, v39
    v_rcp_f32 v43, v39
    s_nop 0
    v_pk_add_f32 v[44:45], v[64:65], v[32:33] neg_lo:[0,1] neg_hi:[0,1]
    v_pk_add_f32 v[46:47], v[66:67], v[34:35] neg_lo:[0,1] neg_hi:[0,1]
    v_cvt_pk_bf16_f32 v6, v44, v45
    v_cvt_pk_bf16_f32 v7, v46, v47
    v_lshlrev_b32 v44, 16, v6
    v_and_b32 v45, 0xffff0000, v6
    v_lshlrev_b32 v46, 16, v7
    v_and_b32 v47, 0xffff0000, v7
    v_pk_mul_f32 v[64:65], v[44:45], v[40:41]
    v_pk_fma_f32 v[44:45], v[64:65], v[36:37], v[44:45] neg_lo:[1,0,0] neg_hi:[1,0,0]
    v_pk_fma_f32 v[64:65], v[44:45], v[40:41], v[64:65]
    v_pk_mul_f32 v[66:67], v[46:47], v[42:43]
    v_pk_fma_f32 v[46:47], v[66:67], v[38:39], v[46:47] neg_lo:[1,0,0] neg_hi:[1,0,0]
    v_pk_fma_f32 v[66:67], v[46:47], v[42:43], v[66:67]
    v_cvt_pk_bf16_f32 v48, v64, v65
    v_cvt_pk_bf16_f32 v49, v66, v67
    buffer_store_dwordx2 v[48:49], v11, s[40:43], 0 offen
    v_pk_add_f32 v[44:45], v[68:69], v[32:33] neg_lo:[0,1] neg_hi:[0,1]
    v_pk_add_f32 v[46:47], v[70:71], v[34:35] neg_lo:[0,1] neg_hi:[0,1]
    v_cvt_pk_bf16_f32 v6, v44, v45
    v_cvt_pk_bf16_f32 v7, v46, v47
    v_lshlrev_b32 v44, 16, v6
    v_and_b32 v45, 0xffff0000, v6
    v_lshlrev_b32 v46, 16, v7
    v_and_b32 v47, 0xffff0000, v7
    v_pk_mul_f32 v[68:69], v[44:45], v[40:41]
    v_pk_fma_f32 v[44:45], v[68:69], v[36:37], v[44:45] neg_lo:[1,0,0] neg_hi:[1,0,0]
    v_pk_fma_f32 v[68:69], v[44:45], v[40:41], v[68:69]
    v_pk_mul_f32 v[70:71], v[46:47], v[42:43]
    v_pk_fma_f32 v[46:47], v[70:71], v[38:39], v[46:47] neg_lo:[1,0,0] neg_hi:[1,0,0]
    v_pk_fma_f32 v[70:71], v[46:47], v[42:43], v[70:71]
    v_cvt_pk_bf16_f32 v50, v68, v69
    v_cvt_pk_bf16_f32 v51, v70, v71
    s_mov_b32 s52, 0x10000
    buffer_store_dwordx2 v[50:51], v11, s[40:43], s52 offen
    v_pk_add_f32 v[44:45], v[72:73], v[32:33] neg_lo:[0,1] neg_hi:[0,1]
    v_pk_add_f32 v[46:47], v[74:75], v[34:35] neg_lo:[0,1] neg_hi:[0,1]
    v_cvt_pk_bf16_f32 v6, v44, v45
    v_cvt_pk_bf16_f32 v7, v46, v47
    v_lshlrev_b32 v44, 16, v6
    v_and_b32 v45, 0xffff0000, v6
    v_lshlrev_b32 v46, 16, v7
    v_and_b32 v47, 0xffff0000, v7
    v_pk_mul_f32 v[72:73], v[44:45], v[40:41]
    v_pk_fma_f32 v[44:45], v[72:73], v[36:37], v[44:45] neg_lo:[1,0,0] neg_hi:[1,0,0]
    v_pk_fma_f32 v[72:73], v[44:45], v[40:41], v[72:73]
    v_pk_mul_f32 v[74:75], v[46:47], v[42:43]
    v_pk_fma_f32 v[46:47], v[74:75], v[38:39], v[46:47] neg_lo:[1,0,0] neg_hi:[1,0,0]
    v_pk_fma_f32 v[74:75], v[46:47], v[42:43], v[74:75]
    v_cvt_pk_bf16_f32 v48, v72, v73
    v_cvt_pk_bf16_f32 v49, v74, v75
    s_mov_b32 s52, 0x20000
    buffer_store_dwordx2 v[48:49], v11, s[40:43], s52 offen
    v_pk_add_f32 v[44:45], v[76:77], v[32:33] neg_lo:[0,1] neg_hi:[0,1]
    v_pk_add_f32 v[46:47], v[78:79], v[34:35] neg_lo:[0,1] neg_hi:[0,1]
    v_cvt_pk_bf16_f32 v6, v44, v45
    v_cvt_pk_bf16_f32 v7, v46, v47
    v_lshlrev_b32 v44, 16, v6
    v_and_b32 v45, 0xffff0000, v6
    v_lshlrev_b32 v46, 16, v7
    v_and_b32 v47, 0xffff0000, v7
    v_pk_mul_f32 v[76:77], v[44:45], v[40:41]
    v_pk_fma_f32 v[44:45], v[76:77], v[36:37], v[44:45] neg_lo:[1,0,0] neg_hi:[1,0,0]
    v_pk_fma_f32 v[76:77], v[44:45], v[40:41], v[76:77]
    v_pk_mul_f32 v[78:79], v[46:47], v[42:43]
    v_pk_fma_f32 v[46:47], v[78:79], v[38:39], v[46:47] neg_lo:[1,0,0] neg_hi:[1,0,0]
    v_pk_fma_f32 v[78:79], v[46:47], v[42:43], v[78:79]
    v_cvt_pk_bf16_f32 v50, v76, v77
    v_cvt_pk_bf16_f32 v51, v78, v79
    s_mov_b32 s52, 0x30000
    buffer_store_dwordx2 v[50:51], v11, s[40:43], s52 offen
    s_endpgm
k1_loader:
    s_sub_u32 s9, s8, 8
    s_lshl_b32 s11, s5, 6
    s_lshl_b32 s12, s9, 4
    s_add_u32 s11, s11, s12
    v_lshrrev_b32 v12, 3, v0
    v_add_u32 v12, 0, v12
    v_add_u32 v12, s11, v12
    v_mul_u32_u24 v12, 896, v12
    v_add_u32 v13, 0, v2
    v_and_b32 v14, 7, v0
    v_xor_b32 v13, v13, v14
    v_lshl_add_u32 v4, v13, 4, v12
    v_lshrrev_b32 v12, 3, v0
    v_add_u32 v12, 8, v12
    v_add_u32 v12, s11, v12
    v_mul_u32_u24 v12, 896, v12
    v_add_u32 v13, 4, v2
    v_and_b32 v14, 7, v0
    v_xor_b32 v13, v13, v14
    v_lshl_add_u32 v5, v13, 4, v12
    s_lshl_b32 s13, s9, 4
    s_lshl_b32 s14, s6, 8
    v_add_u32 v12, 0, v2
    v_add_u32 v12, s13, v12
    v_mul_u32_u24 v12, 3584, v12
    v_or_b32 v13, 0, v2
    v_lshrrev_b32 v14, 1, v1
    v_xor_b32 v13, v13, v14
    v_and_b32 v14, 1, v0
    v_lshl_add_u32 v13, v13, 1, v14
    v_lshl_add_u32 v12, v13, 4, v12
    v_add_u32 v6, s14, v12
    v_add_u32 v12, 4, v2
    v_add_u32 v12, s13, v12
    v_mul_u32_u24 v12, 3584, v12
    v_or_b32 v13, 0, v2
    v_lshrrev_b32 v14, 1, v1
    v_xor_b32 v13, v13, v14
    v_and_b32 v14, 1, v0
    v_lshl_add_u32 v13, v13, 1, v14
    v_lshl_add_u32 v12, v13, 4, v12
    v_add_u32 v7, s14, v12
    v_add_u32 v12, 8, v2
    v_add_u32 v12, s13, v12
    v_mul_u32_u24 v12, 3584, v12
    v_or_b32 v13, 4, v2
    v_lshrrev_b32 v14, 1, v1
    v_xor_b32 v13, v13, v14
    v_and_b32 v14, 1, v0
    v_lshl_add_u32 v13, v13, 1, v14
    v_lshl_add_u32 v12, v13, 4, v12
    v_add_u32 v8, s14, v12
    v_add_u32 v12, 12, v2
    v_add_u32 v12, s13, v12
    v_mul_u32_u24 v12, 3584, v12
    v_or_b32 v13, 4, v2
    v_lshrrev_b32 v14, 1, v1
    v_xor_b32 v13, v13, v14
    v_and_b32 v14, 1, v0
    v_lshl_add_u32 v13, v13, 1, v14
    v_lshl_add_u32 v12, v13, 4, v12
    v_add_u32 v9, s14, v12
    s_lshl_b32 s48, s9, 11
    s_lshl_b32 s49, s9, 12
    s_waitcnt lgkmcnt(0)
    s_mov_b32 s32, s16
    s_and_b32 s33, s17, 0xffff
    s_mov_b32 s34, 0x1c0000
    s_mov_b32 s35, 0x00020000
    s_mov_b32 s36, s18
    s_and_b32 s37, s19, 0xffff
    s_mov_b32 s38, 0x188000
    s_mov_b32 s39, 0x00020000
    s_mov_b32 s50, 0
    s_movk_i32 s51, 1792
    s_mov_b32 s93, 0
    s_add_u32 s94, s93, s48
    s_add_u32 s95, s93, s49
    s_add_u32 m0, s94, 0
    s_nop 0
    buffer_load_dwordx4 v4, s[32:35], s50 offen lds
    s_add_u32 m0, s94, 1024
    s_nop 0
    buffer_load_dwordx4 v5, s[32:35], s50 offen lds
    s_add_u32 m0, s95, 8192
    s_nop 0
    buffer_load_dwordx4 v6, s[36:39], s51 offen lds
    s_add_u32 m0, s95, 9216
    s_nop 0
    buffer_load_dwordx4 v7, s[36:39], s51 offen lds
    s_add_u32 m0, s95, 10240
    s_nop 0
    buffer_load_dwordx4 v8, s[36:39], s51 offen lds
    s_add_u32 m0, s95, 11264
    s_nop 0
    buffer_load_dwordx4 v9, s[36:39], s51 offen lds
    s_add_u32 s50, s50, 128
    s_add_u32 s51, s51, 229376
    s_cmp_eq_u32 s50, 896
    s_cselect_b32 s50, 0, s50
    s_cselect_b32 s51, 0, s51
    s_add_u32 s93, s93, 24576
    s_cmp_ge_u32 s93, 147456
    s_cselect_b32 s93, 0, s93
    s_add_u32 s94, s93, s48
    s_add_u32 s95, s93, s49
    s_add_u32 m0, s94, 0
    s_nop 0
    buffer_load_dwordx4 v4, s[32:35], s50 offen lds
    s_add_u32 m0, s94, 1024
    s_nop 0
    buffer_load_dwordx4 v5, s[32:35], s50 offen lds
    s_add_u32 m0, s95, 8192
    s_nop 0
    buffer_load_dwordx4 v6, s[36:39], s51 offen lds
    s_add_u32 m0, s95, 9216
    s_nop 0
    buffer_load_dwordx4 v7, s[36:39], s51 offen lds
    s_add_u32 m0, s95, 10240
    s_nop 0
    buffer_load_dwordx4 v8, s[36:39], s51 offen lds
    s_add_u32 m0, s95, 11264
    s_nop 0
    buffer_load_dwordx4 v9, s[36:39], s51 offen lds
    s_add_u32 s50, s50, 128
    s_add_u32 s51, s51, 229376
    s_cmp_eq_u32 s50, 896
    s_cselect_b32 s50, 0, s50
    s_cselect_b32 s51, 0, s51
    s_add_u32 s93, s93, 24576
    s_cmp_ge_u32 s93, 147456
    s_cselect_b32 s93, 0, s93
    s_add_u32 s94, s93, s48
    s_add_u32 s95, s93, s49
    s_add_u32 m0, s94, 0
    s_nop 0
    buffer_load_dwordx4 v4, s[32:35], s50 offen lds
    s_add_u32 m0, s94, 1024
    s_nop 0
    buffer_load_dwordx4 v5, s[32:35], s50 offen lds
    s_add_u32 m0, s95, 8192
    s_nop 0
    buffer_load_dwordx4 v6, s[36:39], s51 offen lds
    s_add_u32 m0, s95, 9216
    s_nop 0
    buffer_load_dwordx4 v7, s[36:39], s51 offen lds
    s_add_u32 m0, s95, 10240
    s_nop 0
    buffer_load_dwordx4 v8, s[36:39], s51 offen lds
    s_add_u32 m0, s95, 11264
    s_nop 0
    buffer_load_dwordx4 v9, s[36:39], s51 offen lds
    s_add_u32 s50, s50, 128
    s_add_u32 s51, s51, 229376
    s_cmp_eq_u32 s50, 896
    s_cselect_b32 s50, 0, s50
    s_cselect_b32 s51, 0, s51
    s_add_u32 s93, s93, 24576
    s_cmp_ge_u32 s93, 147456
    s_cselect_b32 s93, 0, s93
    s_waitcnt vmcnt(12)
    s_barrier
    s_add_u32 s94, s93, s48
    s_add_u32 s95, s93, s49
    s_add_u32 m0, s94, 0
    s_nop 0
    buffer_load_dwordx4 v4, s[32:35], s50 offen lds
    s_add_u32 m0, s94, 1024
    s_nop 0
    buffer_load_dwordx4 v5, s[32:35], s50 offen lds
    s_add_u32 m0, s95, 8192
    s_nop 0
    buffer_load_dwordx4 v6, s[36:39], s51 offen lds
    s_add_u32 m0, s95, 9216
    s_nop 0
    buffer_load_dwordx4 v7, s[36:39], s51 offen lds
    s_add_u32 m0, s95, 10240
    s_nop 0
    buffer_load_dwordx4 v8, s[36:39], s51 offen lds
    s_add_u32 m0, s95, 11264
    s_nop 0
    buffer_load_dwordx4 v9, s[36:39], s51 offen lds
    s_add_u32 s50, s50, 128
    s_add_u32 s51, s51, 229376
    s_cmp_eq_u32 s50, 896
    s_cselect_b32 s50, 0, s50
    s_cselect_b32 s51, 0, s51
    s_add_u32 s93, s93, 24576
    s_cmp_ge_u32 s93, 147456
    s_cselect_b32 s93, 0, s93
    s_add_u32 s94, s93, s48
    s_add_u32 s95, s93, s49
    s_add_u32 m0, s94, 0
    s_nop 0
    buffer_load_dwordx4 v4, s[32:35], s50 offen lds
    s_add_u32 m0, s94, 1024
    s_nop 0
    buffer_load_dwordx4 v5, s[32:35], s50 offen lds
    s_add_u32 m0, s95, 8192
    s_nop 0
    buffer_load_dwordx4 v6, s[36:39], s51 offen lds
    s_add_u32 m0, s95, 9216
    s_nop 0
    buffer_load_dwordx4 v7, s[36:39], s51 offen lds
    s_add_u32 m0, s95, 10240
    s_nop 0
    buffer_load_dwordx4 v8, s[36:39], s51 offen lds
    s_add_u32 m0, s95, 11264
    s_nop 0
    buffer_load_dwordx4 v9, s[36:39], s51 offen lds
    s_add_u32 s50, s50, 128
    s_add_u32 s51, s51, 229376
    s_cmp_eq_u32 s50, 896
    s_cselect_b32 s50, 0, s50
    s_cselect_b32 s51, 0, s51
    s_add_u32 s93, s93, 24576
    s_cmp_ge_u32 s93, 147456
    s_cselect_b32 s93, 0, s93
    s_waitcnt vmcnt(18)
    s_barrier
    s_add_u32 s94, s93, s48
    s_add_u32 s95, s93, s49
    s_add_u32 m0, s94, 0
    s_nop 0
    buffer_load_dwordx4 v4, s[32:35], s50 offen lds
    s_add_u32 m0, s94, 1024
    s_nop 0
    buffer_load_dwordx4 v5, s[32:35], s50 offen lds
    s_add_u32 m0, s95, 8192
    s_nop 0
    buffer_load_dwordx4 v6, s[36:39], s51 offen lds
    s_add_u32 m0, s95, 9216
    s_nop 0
    buffer_load_dwordx4 v7, s[36:39], s51 offen lds
    s_add_u32 m0, s95, 10240
    s_nop 0
    buffer_load_dwordx4 v8, s[36:39], s51 offen lds
    s_add_u32 m0, s95, 11264
    s_nop 0
    buffer_load_dwordx4 v9, s[36:39], s51 offen lds
    s_add_u32 s50, s50, 128
    s_add_u32 s51, s51, 229376
    s_cmp_eq_u32 s50, 896
    s_cselect_b32 s50, 0, s50
    s_cselect_b32 s51, 0, s51
    s_add_u32 s93, s93, 24576
    s_cmp_ge_u32 s93, 147456
    s_cselect_b32 s93, 0, s93
    s_add_u32 s94, s93, s48
    s_add_u32 s95, s93, s49
    s_add_u32 m0, s94, 0
    s_nop 0
    buffer_load_dwordx4 v4, s[32:35], s50 offen lds
    s_add_u32 m0, s94, 1024
    s_nop 0
    buffer_load_dwordx4 v5, s[32:35], s50 offen lds
    s_add_u32 m0, s95, 8192
    s_nop 0
    buffer_load_dwordx4 v6, s[36:39], s51 offen lds
    s_add_u32 m0, s95, 9216
    s_nop 0
    buffer_load_dwordx4 v7, s[36:39], s51 offen lds
    s_add_u32 m0, s95, 10240
    s_nop 0
    buffer_load_dwordx4 v8, s[36:39], s51 offen lds
    s_add_u32 m0, s95, 11264
    s_nop 0
    buffer_load_dwordx4 v9, s[36:39], s51 offen lds
    s_add_u32 s50, s50, 128
    s_add_u32 s51, s51, 229376
    s_cmp_eq_u32 s50, 896
    s_cselect_b32 s50, 0, s50
    s_cselect_b32 s51, 0, s51
    s_add_u32 s93, s93, 24576
    s_cmp_ge_u32 s93, 147456
    s_cselect_b32 s93, 0, s93
    s_movk_i32 s92, 7
ldl3:
    s_waitcnt vmcnt(24)
    s_barrier
    s_add_u32 s94, s93, s48
    s_add_u32 s95, s93, s49
    s_add_u32 m0, s94, 0
    s_nop 0
    buffer_load_dwordx4 v4, s[32:35], s50 offen lds
    s_add_u32 m0, s94, 1024
    s_nop 0
    buffer_load_dwordx4 v5, s[32:35], s50 offen lds
    s_add_u32 m0, s95, 8192
    s_nop 0
    buffer_load_dwordx4 v6, s[36:39], s51 offen lds
    s_add_u32 m0, s95, 9216
    s_nop 0
    buffer_load_dwordx4 v7, s[36:39], s51 offen lds
    s_add_u32 m0, s95, 10240
    s_nop 0
    buffer_load_dwordx4 v8, s[36:39], s51 offen lds
    s_add_u32 m0, s95, 11264
    s_nop 0
    buffer_load_dwordx4 v9, s[36:39], s51 offen lds
    s_add_u32 s50, s50, 128
    s_add_u32 s51, s51, 229376
    s_cmp_eq_u32 s50, 896
    s_cselect_b32 s50, 0, s50
    s_cselect_b32 s51, 0, s51
    s_add_u32 s93, s93, 24576
    s_cmp_ge_u32 s93, 147456
    s_cselect_b32 s93, 0, s93
    s_sub_u32 s92, s92, 1
    s_cmp_lg_u32 s92, 0
    s_cbranch_scc1 ldl3
    s_waitcnt vmcnt(24)
    s_barrier
    s_waitcnt vmcnt(18)
    s_barrier
    s_waitcnt vmcnt(12)
    s_barrier
    s_waitcnt vmcnt(6)
    s_barrier
    s_waitcnt vmcnt(0)
    s_barrier
    s_endpgm
k1_pf:
    s_cmp_ge_u32 s8, 8
    s_cbranch_scc1 k1_kernel_done
    s_and_b32 s3, s2, 3
    s_lshl_b32 s3, s3, 21
    s_sub_u32 s4, s2, 224
    s_lshr_b32 s5, s4, 3
    s_lshl_b32 s5, s5, 19
    s_add_u32 s3, s3, s5
    s_lshl_b32 s5, s8, 16
    s_add_u32 s3, s3, s5
    s_lshl_b32 s4, s4, 3
    s_add_u32 s4, s4, s8
    s_mul_i32 s4, s4, 3136
    v_lshlrev_b32 v3, 4, v0
    s_lshl_b32 s6, s8, 12
    s_waitcnt lgkmcnt(0)
    s_mov_b32 s32, s20
    s_and_b32 s33, s21, 0xffff
    s_mov_b32 s34, 0x800000
    s_mov_b32 s35, 0x00020000
    s_mov_b32 s36, s24
    s_and_b32 s37, s25, 0xffff
    s_mov_b32 s38, 0xc4000
    s_mov_b32 s39, 0x00020000
    s_mov_b32 m0, s6
    buffer_load_dwordx4 v3, s[36:39], s4 offen offset:0 lds
    buffer_load_dwordx4 v3, s[36:39], s4 offen offset:1024 lds
    buffer_load_dwordx4 v3, s[36:39], s4 offen offset:2048 lds
    buffer_load_dwordx4 v3, s[36:39], s4 offen offset:3072 lds
    buffer_load_dwordx4 v3, s[32:35], s3 offen offset:0 lds
    buffer_load_dwordx4 v3, s[32:35], s3 offen offset:1024 lds
    buffer_load_dwordx4 v3, s[32:35], s3 offen offset:2048 lds
    buffer_load_dwordx4 v3, s[32:35], s3 offen offset:3072 lds
    s_add_u32 s3, s3, 4096
    buffer_load_dwordx4 v3, s[32:35], s3 offen offset:0 lds
    buffer_load_dwordx4 v3, s[32:35], s3 offen offset:1024 lds
    s_waitcnt vmcnt(6)
    buffer_load_dwordx4 v3, s[32:35], s3 offen offset:2048 lds
    s_waitcnt vmcnt(6)
    buffer_load_dwordx4 v3, s[32:35], s3 offen offset:3072 lds
    s_add_u32 s3, s3, 4096
    s_waitcnt vmcnt(6)
    buffer_load_dwordx4 v3, s[32:35], s3 offen offset:0 lds
    s_waitcnt vmcnt(6)
    buffer_load_dwordx4 v3, s[32:35], s3 offen offset:1024 lds
    s_waitcnt vmcnt(6)
    buffer_load_dwordx4 v3, s[32:35], s3 offen offset:2048 lds
    s_waitcnt vmcnt(6)
    buffer_load_dwordx4 v3, s[32:35], s3 offen offset:3072 lds
    s_add_u32 s3, s3, 4096
    s_waitcnt vmcnt(6)
    buffer_load_dwordx4 v3, s[32:35], s3 offen offset:0 lds
    s_waitcnt vmcnt(6)
    buffer_load_dwordx4 v3, s[32:35], s3 offen offset:1024 lds
    s_waitcnt vmcnt(6)
    buffer_load_dwordx4 v3, s[32:35], s3 offen offset:2048 lds
    s_waitcnt vmcnt(6)
    buffer_load_dwordx4 v3, s[32:35], s3 offen offset:3072 lds
    s_add_u32 s3, s3, 4096
    s_waitcnt vmcnt(6)
    buffer_load_dwordx4 v3, s[32:35], s3 offen offset:0 lds
    s_waitcnt vmcnt(6)
    buffer_load_dwordx4 v3, s[32:35], s3 offen offset:1024 lds
    s_waitcnt vmcnt(6)
    buffer_load_dwordx4 v3, s[32:35], s3 offen offset:2048 lds
    s_waitcnt vmcnt(6)
    buffer_load_dwordx4 v3, s[32:35], s3 offen offset:3072 lds
    s_add_u32 s3, s3, 4096
    s_waitcnt vmcnt(6)
    buffer_load_dwordx4 v3, s[32:35], s3 offen offset:0 lds
    s_waitcnt vmcnt(6)
    buffer_load_dwordx4 v3, s[32:35], s3 offen offset:1024 lds
    s_waitcnt vmcnt(6)
    buffer_load_dwordx4 v3, s[32:35], s3 offen offset:2048 lds
    s_waitcnt vmcnt(6)
    buffer_load_dwordx4 v3, s[32:35], s3 offen offset:3072 lds
    s_add_u32 s3, s3, 4096
    s_waitcnt vmcnt(6)
    buffer_load_dwordx4 v3, s[32:35], s3 offen offset:0 lds
    s_waitcnt vmcnt(6)
    buffer_load_dwordx4 v3, s[32:35], s3 offen offset:1024 lds
    s_waitcnt vmcnt(6)
    buffer_load_dwordx4 v3, s[32:35], s3 offen offset:2048 lds
    s_waitcnt vmcnt(6)
    buffer_load_dwordx4 v3, s[32:35], s3 offen offset:3072 lds
    s_add_u32 s3, s3, 4096
    s_waitcnt vmcnt(6)
    buffer_load_dwordx4 v3, s[32:35], s3 offen offset:0 lds
    s_waitcnt vmcnt(6)
    buffer_load_dwordx4 v3, s[32:35], s3 offen offset:1024 lds
    s_waitcnt vmcnt(6)
    buffer_load_dwordx4 v3, s[32:35], s3 offen offset:2048 lds
    s_waitcnt vmcnt(6)
    buffer_load_dwordx4 v3, s[32:35], s3 offen offset:3072 lds
    s_add_u32 s3, s3, 4096
    s_waitcnt vmcnt(6)
    buffer_load_dwordx4 v3, s[32:35], s3 offen offset:0 lds
    s_waitcnt vmcnt(6)
    buffer_load_dwordx4 v3, s[32:35], s3 offen offset:1024 lds
    s_waitcnt vmcnt(6)
    buffer_load_dwordx4 v3, s[32:35], s3 offen offset:2048 lds
    s_waitcnt vmcnt(6)
    buffer_load_dwordx4 v3, s[32:35], s3 offen offset:3072 lds
    s_add_u32 s3, s3, 4096
    s_waitcnt vmcnt(6)
    buffer_load_dwordx4 v3, s[32:35], s3 offen offset:0 lds
    s_waitcnt vmcnt(6)
    buffer_load_dwordx4 v3, s[32:35], s3 offen offset:1024 lds
    s_waitcnt vmcnt(6)
    buffer_load_dwordx4 v3, s[32:35], s3 offen offset:2048 lds
    s_waitcnt vmcnt(6)
    buffer_load_dwordx4 v3, s[32:35], s3 offen offset:3072 lds
    s_add_u32 s3, s3, 4096
    s_waitcnt vmcnt(6)
    buffer_load_dwordx4 v3, s[32:35], s3 offen offset:0 lds
    s_waitcnt vmcnt(6)
    buffer_load_dwordx4 v3, s[32:35], s3 offen offset:1024 lds
    s_waitcnt vmcnt(6)
    buffer_load_dwordx4 v3, s[32:35], s3 offen offset:2048 lds
    s_waitcnt vmcnt(6)
    buffer_load_dwordx4 v3, s[32:35], s3 offen offset:3072 lds
    s_add_u32 s3, s3, 4096
    s_waitcnt vmcnt(6)
    buffer_load_dwordx4 v3, s[32:35], s3 offen offset:0 lds
    s_waitcnt vmcnt(6)
    buffer_load_dwordx4 v3, s[32:35], s3 offen offset:1024 lds
    s_waitcnt vmcnt(6)
    buffer_load_dwordx4 v3, s[32:35], s3 offen offset:2048 lds
    s_waitcnt vmcnt(6)
    buffer_load_dwordx4 v3, s[32:35], s3 offen offset:3072 lds
    s_add_u32 s3, s3, 4096
    s_waitcnt vmcnt(6)
    buffer_load_dwordx4 v3, s[32:35], s3 offen offset:0 lds
    s_waitcnt vmcnt(6)
    buffer_load_dwordx4 v3, s[32:35], s3 offen offset:1024 lds
    s_waitcnt vmcnt(6)
    buffer_load_dwordx4 v3, s[32:35], s3 offen offset:2048 lds
    s_waitcnt vmcnt(6)
    buffer_load_dwordx4 v3, s[32:35], s3 offen offset:3072 lds
    s_add_u32 s3, s3, 4096
    s_waitcnt vmcnt(6)
    buffer_load_dwordx4 v3, s[32:35], s3 offen offset:0 lds
    s_waitcnt vmcnt(6)
    buffer_load_dwordx4 v3, s[32:35], s3 offen offset:1024 lds
    s_waitcnt vmcnt(6)
    buffer_load_dwordx4 v3, s[32:35], s3 offen offset:2048 lds
    s_waitcnt vmcnt(6)
    buffer_load_dwordx4 v3, s[32:35], s3 offen offset:3072 lds
    s_add_u32 s3, s3, 4096
    s_waitcnt vmcnt(6)
    buffer_load_dwordx4 v3, s[32:35], s3 offen offset:0 lds
    s_waitcnt vmcnt(6)
    buffer_load_dwordx4 v3, s[32:35], s3 offen offset:1024 lds
    s_waitcnt vmcnt(6)
    buffer_load_dwordx4 v3, s[32:35], s3 offen offset:2048 lds
    s_waitcnt vmcnt(6)
    buffer_load_dwordx4 v3, s[32:35], s3 offen offset:3072 lds
    s_add_u32 s3, s3, 4096
    s_waitcnt vmcnt(6)
    buffer_load_dwordx4 v3, s[32:35], s3 offen offset:0 lds
    s_waitcnt vmcnt(6)
    buffer_load_dwordx4 v3, s[32:35], s3 offen offset:1024 lds
    s_waitcnt vmcnt(6)
    buffer_load_dwordx4 v3, s[32:35], s3 offen offset:2048 lds
    s_waitcnt vmcnt(6)
    buffer_load_dwordx4 v3, s[32:35], s3 offen offset:3072 lds
    s_waitcnt vmcnt(0)
k1_kernel_done:
    s_endpgm
.globl k3_kernel
.p2align 8
.type k3_kernel,@function
k3_kernel:
    s_cmp_ge_u32 s2, 256
    s_cbranch_scc1 k3_kernel_done
    s_load_dwordx16 s[16:31], s[0:1], 0
    v_lshrrev_b32 v1, 6, v0
    v_and_b32 v0, 63, v0
    v_readfirstlane_b32 s8, v1
    v_and_b32 v1, 15, v0
    v_lshrrev_b32 v2, 4, v0
    s_and_b32 s3, s2, 7
    s_lshr_b32 s4, s2, 3
    s_and_b32 s5, s3, 3
    s_lshl_b32 s5, s5, 3
    s_and_b32 s6, s4, 7
    s_add_u32 s5, s5, s6
    s_lshr_b32 s6, s3, 2
    s_lshl_b32 s6, s6, 2
    s_lshr_b32 s7, s4, 3
    s_add_u32 s6, s6, s7
    s_mul_i32 s9, s6, 7
    s_cmp_ge_u32 s8, 4
    s_cbranch_scc1 k3_loader
    s_lshl_b32 s10, s8, 1
    s_add_u32 s9, s9, s10

    v_lshrrev_b32 v10, 1, v1
    v_xor_b32 v10, v10, v2
    v_lshlrev_b32 v11, 7, v1
    v_lshl_add_u32 v13, v10, 4, v11
    v_xor_b32 v14, 64, v13
    s_lshl_b32 s12, s8, 12
    s_add_u32 s12, s12, 8192
    v_lshl_add_u32 v21, v0, 4, s12
    s_lshl_b32 s12, s5, 2
    s_mul_i32 s13, s12, 56
    s_add_u32 s13, s13, s9
    s_lshl_b32 s13, s13, 9
    v_lshl_add_u32 v4, v0, 3, s13
    v_lshrrev_b32 v5, 1, v2
    v_lshl_add_u32 v5, v5, 4, v1
    v_lshlrev_b32 v5, 4, v5
    v_and_b32 v10, 1, v2
    v_lshl_add_u32 v5, v10, 3, v5
    s_mul_i32 s13, s12, 28672
    s_lshl_b32 s14, s9, 9
    s_add_u32 s13, s13, s14
    v_add_u32 v5, s13, v5
    s_lshl_b32 s12, s5, 6
    v_add_u32 v10, s12, v1
    v_lshlrev_b32 v10, 1, v10
    v_mov_b32 v76, 0
    v_mov_b32 v77, 0
    v_mov_b32 v78, 0
    v_mov_b32 v79, 0
    v_mov_b32 v80, 0
    v_mov_b32 v81, 0
    v_mov_b32 v82, 0
    v_mov_b32 v83, 0
    v_mov_b32 v84, 0
    v_mov_b32 v85, 0
    v_mov_b32 v86, 0
    v_mov_b32 v87, 0
    v_mov_b32 v88, 0
    v_mov_b32 v89, 0
    v_mov_b32 v90, 0
    v_mov_b32 v91, 0
    v_mov_b32 v92, 0
    v_mov_b32 v93, 0
    v_mov_b32 v94, 0
    v_mov_b32 v95, 0
    v_mov_b32 v96, 0
    v_mov_b32 v97, 0
    v_mov_b32 v98, 0
    v_mov_b32 v99, 0
    v_mov_b32 v100, 0
    v_mov_b32 v101, 0
    v_mov_b32 v102, 0
    v_mov_b32 v103, 0
    v_mov_b32 v104, 0
    v_mov_b32 v105, 0
    v_mov_b32 v106, 0
    v_mov_b32 v107, 0
    s_waitcnt lgkmcnt(0)
    s_mov_b32 s40, s30
    s_and_b32 s41, s31, 0xffff
    s_mov_b32 s42, 0x380000
    s_mov_b32 s43, 0x00020000
    s_add_u32 s44, s30, 0xc00000
    s_addc_u32 s45, s31, 0
    s_and_b32 s45, s45, 0xffff
    s_mov_b32 s46, 0x380000
    s_mov_b32 s47, 0x00020000
    s_mov_b32 s56, s22
    s_and_b32 s57, s23, 0xffff
    s_mov_b32 s58, 0x1000
    s_mov_b32 s59, 0x00020000
    buffer_load_ushort v6, v10, s[56:59], 0 offen offset:0
    buffer_load_ushort v7, v10, s[56:59], 0 offen offset:32
    buffer_load_ushort v8, v10, s[56:59], 0 offen offset:64
    buffer_load_ushort v9, v10, s[56:59], 0 offen offset:96
    s_cmp_eq_u32 s8, 3
    s_cbranch_scc1 k3_w3
    s_mov_b32 s13, 0
    buffer_load_dwordx2 v[108:109], v4, s[40:43], s13 offen offset:0
    buffer_load_dwordx2 v[116:117], v4, s[40:43], s13 offen offset:512
    s_mov_b32 s13, 28672
    buffer_load_dwordx2 v[110:111], v4, s[40:43], s13 offen offset:0
    buffer_load_dwordx2 v[118:119], v4, s[40:43], s13 offen offset:512
    s_mov_b32 s13, 57344
    buffer_load_dwordx2 v[112:113], v4, s[40:43], s13 offen offset:0
    buffer_load_dwordx2 v[120:121], v4, s[40:43], s13 offen offset:512
    s_mov_b32 s13, 86016
    buffer_load_dwordx2 v[114:115], v4, s[40:43], s13 offen offset:0
    buffer_load_dwordx2 v[122:123], v4, s[40:43], s13 offen offset:512
    v_mov_b32 v15, v13
    v_mov_b32 v16, v14
    v_mov_b32 v22, v21
    s_barrier
    ds_read_b128 v[28:31], v15 offset:0
    ds_read_b128 v[32:35], v15 offset:2048
    ds_read_b128 v[36:39], v15 offset:4096
    ds_read_b128 v[40:43], v15 offset:6144
    ds_read_b128 v[60:63], v22 offset:0
    ds_read_b128 v[64:67], v22 offset:2048
    ds_read_b128 v[44:47], v16 offset:0
    ds_read_b128 v[48:51], v16 offset:2048
    ds_read_b128 v[52:55], v16 offset:4096
    ds_read_b128 v[56:59], v16 offset:6144
    ds_read_b128 v[68:71], v22 offset:1024
    ds_read_b128 v[72:75], v22 offset:3072
    s_waitcnt lgkmcnt(6)
    v_mfma_f32_16x16x32_bf16 v[76:79], v[60:63], v[28:31], v[76:79]
    v_mfma_f32_16x16x32_bf16 v[80:83], v[60:63], v[32:35], v[80:83]
    v_mfma_f32_16x16x32_bf16 v[84:87], v[60:63], v[36:39], v[84:87]
    v_mfma_f32_16x16x32_bf16 v[88:91], v[60:63], v[40:43], v[88:91]
    v_mfma_f32_16x16x32_bf16 v[92:95], v[64:67], v[28:31], v[92:95]
    v_mfma_f32_16x16x32_bf16 v[96:99], v[64:67], v[32:35], v[96:99]
    v_mfma_f32_16x16x32_bf16 v[100:103], v[64:67], v[36:39], v[100:103]
    v_mfma_f32_16x16x32_bf16 v[104:107], v[64:67], v[40:43], v[104:107]
    s_waitcnt lgkmcnt(0)
    s_movk_i32 s91, 31
    s_mov_b32 s90, 0
cl4:
    s_add_u32 s90, s90, 22528
    s_cmp_ge_u32 s90, 157696
    s_cselect_b32 s90, 0, s90
    v_add_u32 v15, s90, v13
    v_add_u32 v16, s90, v14
    v_add_u32 v22, s90, v21
    s_barrier
    ds_read_b128 v[28:31], v15 offset:0
    ds_read_b128 v[32:35], v15 offset:2048
    ds_read_b128 v[36:39], v15 offset:4096
    ds_read_b128 v[40:43], v15 offset:6144
    ds_read_b128 v[60:63], v22 offset:0
    ds_read_b128 v[64:67], v22 offset:2048
    v_mfma_f32_16x16x32_bf16 v[76:79], v[68:71], v[44:47], v[76:79]
    v_mfma_f32_16x16x32_bf16 v[80:83], v[68:71], v[48:51], v[80:83]
    v_mfma_f32_16x16x32_bf16 v[84:87], v[68:71], v[52:55], v[84:87]
    v_mfma_f32_16x16x32_bf16 v[88:91], v[68:71], v[56:59], v[88:91]
    v_mfma_f32_16x16x32_bf16 v[92:95], v[72:75], v[44:47], v[92:95]
    v_mfma_f32_16x16x32_bf16 v[96:99], v[72:75], v[48:51], v[96:99]
    v_mfma_f32_16x16x32_bf16 v[100:103], v[72:75], v[52:55], v[100:103]
    v_mfma_f32_16x16x32_bf16 v[104:107], v[72:75], v[56:59], v[104:107]
    ds_read_b128 v[44:47], v16 offset:0
    ds_read_b128 v[48:51], v16 offset:2048
    ds_read_b128 v[52:55], v16 offset:4096
    ds_read_b128 v[56:59], v16 offset:6144
    ds_read_b128 v[68:71], v22 offset:1024
    ds_read_b128 v[72:75], v22 offset:3072
    s_waitcnt lgkmcnt(6)
    v_mfma_f32_16x16x32_bf16 v[76:79], v[60:63], v[28:31], v[76:79]
    v_mfma_f32_16x16x32_bf16 v[80:83], v[60:63], v[32:35], v[80:83]
    v_mfma_f32_16x16x32_bf16 v[84:87], v[60:63], v[36:39], v[84:87]
    v_mfma_f32_16x16x32_bf16 v[88:91], v[60:63], v[40:43], v[88:91]
    v_mfma_f32_16x16x32_bf16 v[92:95], v[64:67], v[28:31], v[92:95]
    v_mfma_f32_16x16x32_bf16 v[96:99], v[64:67], v[32:35], v[96:99]
    v_mfma_f32_16x16x32_bf16 v[100:103], v[64:67], v[36:39], v[100:103]
    v_mfma_f32_16x16x32_bf16 v[104:107], v[64:67], v[40:43], v[104:107]
    s_sub_u32 s91, s91, 1
    s_cmp_lg_u32 s91, 0
    s_waitcnt lgkmcnt(0)
    s_cbranch_scc1 cl4
    v_mfma_f32_16x16x32_bf16 v[76:79], v[68:71], v[44:47], v[76:79]
    v_mfma_f32_16x16x32_bf16 v[80:83], v[68:71], v[48:51], v[80:83]
    v_mfma_f32_16x16x32_bf16 v[84:87], v[68:71], v[52:55], v[84:87]
    v_mfma_f32_16x16x32_bf16 v[88:91], v[68:71], v[56:59], v[88:91]
    v_mfma_f32_16x16x32_bf16 v[92:95], v[72:75], v[44:47], v[92:95]
    v_mfma_f32_16x16x32_bf16 v[96:99], v[72:75], v[48:51], v[96:99]
    v_mfma_f32_16x16x32_bf16 v[100:103], v[72:75], v[52:55], v[100:103]
    v_mfma_f32_16x16x32_bf16 v[104:107], v[72:75], v[56:59], v[104:107]
    s_nop 7
    s_nop 7
    s_waitcnt vmcnt(0)
    v_lshlrev_b32 v6, 16, v6
    v_lshlrev_b32 v7, 16, v7
    v_lshlrev_b32 v8, 16, v8
    v_lshlrev_b32 v9, 16, v9
    v_cvt_pk_bf16_f32 v32, v76, v77
    v_cvt_pk_bf16_f32 v33, v78, v79
    v_lshlrev_b32 v28, 16, v32
    v_and_b32 v29, 0xffff0000, v32
    v_lshlrev_b32 v30, 16, v33
    v_and_b32 v31, 0xffff0000, v33
    v_add_f32 v28, v28, v6
    v_add_f32 v29, v29, v6
    v_add_f32 v30, v30, v6
    v_add_f32 v31, v31, v6
    v_cvt_pk_bf16_f32 v32, v28, v29
    v_cvt_pk_bf16_f32 v33, v30, v31
    v_lshlrev_b32 v28, 16, v32
    v_and_b32 v29, 0xffff0000, v32
    v_lshlrev_b32 v30, 16, v33
    v_and_b32 v31, 0xffff0000, v33
    v_lshlrev_b32 v34, 16, v108
    v_and_b32 v35, 0xffff0000, v108
    v_lshlrev_b32 v36, 16, v109
    v_and_b32 v37, 0xffff0000, v109
    v_mul_f32 v28, v28, v34
    v_mul_f32 v29, v29, v35
    v_mul_f32 v30, v30, v36
    v_mul_f32 v31, v31, v37
    v_cvt_pk_bf16_f32 v38, v28, v29
    v_cvt_pk_bf16_f32 v39, v30, v31
    s_mov_b32 s13, 0
    buffer_store_dwordx2 v[38:39], v5, s[44:47], s13 offen offset:0
    v_cvt_pk_bf16_f32 v32, v80, v81
    v_cvt_pk_bf16_f32 v33, v82, v83
    v_lshlrev_b32 v28, 16, v32
    v_and_b32 v29, 0xffff0000, v32
    v_lshlrev_b32 v30, 16, v33
    v_and_b32 v31, 0xffff0000, v33
    v_add_f32 v28, v28, v7
    v_add_f32 v29, v29, v7
    v_add_f32 v30, v30, v7
    v_add_f32 v31, v31, v7
    v_cvt_pk_bf16_f32 v32, v28, v29
    v_cvt_pk_bf16_f32 v33, v30, v31
    v_lshlrev_b32 v28, 16, v32
    v_and_b32 v29, 0xffff0000, v32
    v_lshlrev_b32 v30, 16, v33
    v_and_b32 v31, 0xffff0000, v33
    v_lshlrev_b32 v34, 16, v110
    v_and_b32 v35, 0xffff0000, v110
    v_lshlrev_b32 v36, 16, v111
    v_and_b32 v37, 0xffff0000, v111
    v_mul_f32 v28, v28, v34
    v_mul_f32 v29, v29, v35
    v_mul_f32 v30, v30, v36
    v_mul_f32 v31, v31, v37
    v_cvt_pk_bf16_f32 v40, v28, v29
    v_cvt_pk_bf16_f32 v41, v30, v31
    s_mov_b32 s13, 28672
    buffer_store_dwordx2 v[40:41], v5, s[44:47], s13 offen offset:0
    v_cvt_pk_bf16_f32 v32, v84, v85
    v_cvt_pk_bf16_f32 v33, v86, v87
    v_lshlrev_b32 v28, 16, v32
    v_and_b32 v29, 0xffff0000, v32
    v_lshlrev_b32 v30, 16, v33
    v_and_b32 v31, 0xffff0000, v33
    v_add_f32 v28, v28, v8
    v_add_f32 v29, v29, v8
    v_add_f32 v30, v30, v8
    v_add_f32 v31, v31, v8
    v_cvt_pk_bf16_f32 v32, v28, v29
    v_cvt_pk_bf16_f32 v33, v30, v31
    v_lshlrev_b32 v28, 16, v32
    v_and_b32 v29, 0xffff0000, v32
    v_lshlrev_b32 v30, 16, v33
    v_and_b32 v31, 0xffff0000, v33
    v_lshlrev_b32 v34, 16, v112
    v_and_b32 v35, 0xffff0000, v112
    v_lshlrev_b32 v36, 16, v113
    v_and_b32 v37, 0xffff0000, v113
    v_mul_f32 v28, v28, v34
    v_mul_f32 v29, v29, v35
    v_mul_f32 v30, v30, v36
    v_mul_f32 v31, v31, v37
    v_cvt_pk_bf16_f32 v42, v28, v29
    v_cvt_pk_bf16_f32 v43, v30, v31
    s_mov_b32 s13, 57344
    buffer_store_dwordx2 v[42:43], v5, s[44:47], s13 offen offset:0
    v_cvt_pk_bf16_f32 v32, v88, v89
    v_cvt_pk_bf16_f32 v33, v90, v91
    v_lshlrev_b32 v28, 16, v32
    v_and_b32 v29, 0xffff0000, v32
    v_lshlrev_b32 v30, 16, v33
    v_and_b32 v31, 0xffff0000, v33
    v_add_f32 v28, v28, v9
    v_add_f32 v29, v29, v9
    v_add_f32 v30, v30, v9
    v_add_f32 v31, v31, v9
    v_cvt_pk_bf16_f32 v32, v28, v29
    v_cvt_pk_bf16_f32 v33, v30, v31
    v_lshlrev_b32 v28, 16, v32
    v_and_b32 v29, 0xffff0000, v32
    v_lshlrev_b32 v30, 16, v33
    v_and_b32 v31, 0xffff0000, v33
    v_lshlrev_b32 v34, 16, v114
    v_and_b32 v35, 0xffff0000, v114
    v_lshlrev_b32 v36, 16, v115
    v_and_b32 v37, 0xffff0000, v115
    v_mul_f32 v28, v28, v34
    v_mul_f32 v29, v29, v35
    v_mul_f32 v30, v30, v36
    v_mul_f32 v31, v31, v37
    v_cvt_pk_bf16_f32 v44, v28, v29
    v_cvt_pk_bf16_f32 v45, v30, v31
    s_mov_b32 s13, 86016
    buffer_store_dwordx2 v[44:45], v5, s[44:47], s13 offen offset:0
    v_cvt_pk_bf16_f32 v32, v92, v93
    v_cvt_pk_bf16_f32 v33, v94, v95
    v_lshlrev_b32 v28, 16, v32
    v_and_b32 v29, 0xffff0000, v32
    v_lshlrev_b32 v30, 16, v33
    v_and_b32 v31, 0xffff0000, v33
    v_add_f32 v28, v28, v6
    v_add_f32 v29, v29, v6
    v_add_f32 v30, v30, v6
    v_add_f32 v31, v31, v6
    v_cvt_pk_bf16_f32 v32, v28, v29
    v_cvt_pk_bf16_f32 v33, v30, v31
    v_lshlrev_b32 v28, 16, v32
    v_and_b32 v29, 0xffff0000, v32
    v_lshlrev_b32 v30, 16, v33
    v_and_b32 v31, 0xffff0000, v33
    v_lshlrev_b32 v34, 16, v116
    v_and_b32 v35, 0xffff0000, v116
    v_lshlrev_b32 v36, 16, v117
    v_and_b32 v37, 0xffff0000, v117
    v_mul_f32 v28, v28, v34
    v_mul_f32 v29, v29, v35
    v_mul_f32 v30, v30, v36
    v_mul_f32 v31, v31, v37
    v_cvt_pk_bf16_f32 v38, v28, v29
    v_cvt_pk_bf16_f32 v39, v30, v31
    s_mov_b32 s13, 0
    buffer_store_dwordx2 v[38:39], v5, s[44:47], s13 offen offset:512
    v_cvt_pk_bf16_f32 v32, v96, v97
    v_cvt_pk_bf16_f32 v33, v98, v99
    v_lshlrev_b32 v28, 16, v32
    v_and_b32 v29, 0xffff0000, v32
    v_lshlrev_b32 v30, 16, v33
    v_and_b32 v31, 0xffff0000, v33
    v_add_f32 v28, v28, v7
    v_add_f32 v29, v29, v7
    v_add_f32 v30, v30, v7
    v_add_f32 v31, v31, v7
    v_cvt_pk_bf16_f32 v32, v28, v29
    v_cvt_pk_bf16_f32 v33, v30, v31
    v_lshlrev_b32 v28, 16, v32
    v_and_b32 v29, 0xffff0000, v32
    v_lshlrev_b32 v30, 16, v33
    v_and_b32 v31, 0xffff0000, v33
    v_lshlrev_b32 v34, 16, v118
    v_and_b32 v35, 0xffff0000, v118
    v_lshlrev_b32 v36, 16, v119
    v_and_b32 v37, 0xffff0000, v119
    v_mul_f32 v28, v28, v34
    v_mul_f32 v29, v29, v35
    v_mul_f32 v30, v30, v36
    v_mul_f32 v31, v31, v37
    v_cvt_pk_bf16_f32 v40, v28, v29
    v_cvt_pk_bf16_f32 v41, v30, v31
    s_mov_b32 s13, 28672
    buffer_store_dwordx2 v[40:41], v5, s[44:47], s13 offen offset:512
    v_cvt_pk_bf16_f32 v32, v100, v101
    v_cvt_pk_bf16_f32 v33, v102, v103
    v_lshlrev_b32 v28, 16, v32
    v_and_b32 v29, 0xffff0000, v32
    v_lshlrev_b32 v30, 16, v33
    v_and_b32 v31, 0xffff0000, v33
    v_add_f32 v28, v28, v8
    v_add_f32 v29, v29, v8
    v_add_f32 v30, v30, v8
    v_add_f32 v31, v31, v8
    v_cvt_pk_bf16_f32 v32, v28, v29
    v_cvt_pk_bf16_f32 v33, v30, v31
    v_lshlrev_b32 v28, 16, v32
    v_and_b32 v29, 0xffff0000, v32
    v_lshlrev_b32 v30, 16, v33
    v_and_b32 v31, 0xffff0000, v33
    v_lshlrev_b32 v34, 16, v120
    v_and_b32 v35, 0xffff0000, v120
    v_lshlrev_b32 v36, 16, v121
    v_and_b32 v37, 0xffff0000, v121
    v_mul_f32 v28, v28, v34
    v_mul_f32 v29, v29, v35
    v_mul_f32 v30, v30, v36
    v_mul_f32 v31, v31, v37
    v_cvt_pk_bf16_f32 v42, v28, v29
    v_cvt_pk_bf16_f32 v43, v30, v31
    s_mov_b32 s13, 57344
    buffer_store_dwordx2 v[42:43], v5, s[44:47], s13 offen offset:512
    v_cvt_pk_bf16_f32 v32, v104, v105
    v_cvt_pk_bf16_f32 v33, v106, v107
    v_lshlrev_b32 v28, 16, v32
    v_and_b32 v29, 0xffff0000, v32
    v_lshlrev_b32 v30, 16, v33
    v_and_b32 v31, 0xffff0000, v33
    v_add_f32 v28, v28, v9
    v_add_f32 v29, v29, v9
    v_add_f32 v30, v30, v9
    v_add_f32 v31, v31, v9
    v_cvt_pk_bf16_f32 v32, v28, v29
    v_cvt_pk_bf16_f32 v33, v30, v31
    v_lshlrev_b32 v28, 16, v32
    v_and_b32 v29, 0xffff0000, v32
    v_lshlrev_b32 v30, 16, v33
    v_and_b32 v31, 0xffff0000, v33
    v_lshlrev_b32 v34, 16, v122
    v_and_b32 v35, 0xffff0000, v122
    v_lshlrev_b32 v36, 16, v123
    v_and_b32 v37, 0xffff0000, v123
    v_mul_f32 v28, v28, v34
    v_mul_f32 v29, v29, v35
    v_mul_f32 v30, v30, v36
    v_mul_f32 v31, v31, v37
    v_cvt_pk_bf16_f32 v44, v28, v29
    v_cvt_pk_bf16_f32 v45, v30, v31
    s_mov_b32 s13, 86016
    buffer_store_dwordx2 v[44:45], v5, s[44:47], s13 offen offset:512
    s_endpgm
k3_w3:
    s_mov_b32 s13, 0
    buffer_load_dwordx2 v[108:109], v4, s[40:43], s13 offen offset:0
    s_mov_b32 s13, 28672
    buffer_load_dwordx2 v[110:111], v4, s[40:43], s13 offen offset:0
    s_mov_b32 s13, 57344
    buffer_load_dwordx2 v[112:113], v4, s[40:43], s13 offen offset:0
    s_mov_b32 s13, 86016
    buffer_load_dwordx2 v[114:115], v4, s[40:43], s13 offen offset:0
    v_mov_b32 v15, v13
    v_mov_b32 v16, v14
    v_mov_b32 v22, v21
    s_barrier
    ds_read_b128 v[28:31], v15 offset:0
    ds_read_b128 v[32:35], v15 offset:2048
    ds_read_b128 v[36:39], v15 offset:4096
    ds_read_b128 v[40:43], v15 offset:6144
    ds_read_b128 v[60:63], v22 offset:0
    ds_read_b128 v[44:47], v16 offset:0
    ds_read_b128 v[48:51], v16 offset:2048
    ds_read_b128 v[52:55], v16 offset:4096
    ds_read_b128 v[56:59], v16 offset:6144
    ds_read_b128 v[68:71], v22 offset:1024
    s_waitcnt lgkmcnt(5)
    v_mfma_f32_16x16x32_bf16 v[76:79], v[60:63], v[28:31], v[76:79]
    v_mfma_f32_16x16x32_bf16 v[80:83], v[60:63], v[32:35], v[80:83]
    v_mfma_f32_16x16x32_bf16 v[84:87], v[60:63], v[36:39], v[84:87]
    v_mfma_f32_16x16x32_bf16 v[88:91], v[60:63], v[40:43], v[88:91]
    s_waitcnt lgkmcnt(0)
    s_movk_i32 s91, 31
    s_mov_b32 s90, 0
cl5:
    s_add_u32 s90, s90, 22528
    s_cmp_ge_u32 s90, 157696
    s_cselect_b32 s90, 0, s90
    v_add_u32 v15, s90, v13
    v_add_u32 v16, s90, v14
    v_add_u32 v22, s90, v21
    s_barrier
    ds_read_b128 v[28:31], v15 offset:0
    ds_read_b128 v[32:35], v15 offset:2048
    ds_read_b128 v[36:39], v15 offset:4096
    ds_read_b128 v[40:43], v15 offset:6144
    ds_read_b128 v[60:63], v22 offset:0
    v_mfma_f32_16x16x32_bf16 v[76:79], v[68:71], v[44:47], v[76:79]
    v_mfma_f32_16x16x32_bf16 v[80:83], v[68:71], v[48:51], v[80:83]
    v_mfma_f32_16x16x32_bf16 v[84:87], v[68:71], v[52:55], v[84:87]
    v_mfma_f32_16x16x32_bf16 v[88:91], v[68:71], v[56:59], v[88:91]
    ds_read_b128 v[44:47], v16 offset:0
    ds_read_b128 v[48:51], v16 offset:2048
    ds_read_b128 v[52:55], v16 offset:4096
    ds_read_b128 v[56:59], v16 offset:6144
    ds_read_b128 v[68:71], v22 offset:1024
    s_waitcnt lgkmcnt(5)
    v_mfma_f32_16x16x32_bf16 v[76:79], v[60:63], v[28:31], v[76:79]
    v_mfma_f32_16x16x32_bf16 v[80:83], v[60:63], v[32:35], v[80:83]
    v_mfma_f32_16x16x32_bf16 v[84:87], v[60:63], v[36:39], v[84:87]
    v_mfma_f32_16x16x32_bf16 v[88:91], v[60:63], v[40:43], v[88:91]
    s_sub_u32 s91, s91, 1
    s_cmp_lg_u32 s91, 0
    s_waitcnt lgkmcnt(0)
    s_cbranch_scc1 cl5
    v_mfma_f32_16x16x32_bf16 v[76:79], v[68:71], v[44:47], v[76:79]
    v_mfma_f32_16x16x32_bf16 v[80:83], v[68:71], v[48:51], v[80:83]
    v_mfma_f32_16x16x32_bf16 v[84:87], v[68:71], v[52:55], v[84:87]
    v_mfma_f32_16x16x32_bf16 v[88:91], v[68:71], v[56:59], v[88:91]
    s_nop 7
    s_nop 7
    s_waitcnt vmcnt(0)
    v_lshlrev_b32 v6, 16, v6
    v_lshlrev_b32 v7, 16, v7
    v_lshlrev_b32 v8, 16, v8
    v_lshlrev_b32 v9, 16, v9
    v_cvt_pk_bf16_f32 v32, v76, v77
    v_cvt_pk_bf16_f32 v33, v78, v79
    v_lshlrev_b32 v28, 16, v32
    v_and_b32 v29, 0xffff0000, v32
    v_lshlrev_b32 v30, 16, v33
    v_and_b32 v31, 0xffff0000, v33
    v_add_f32 v28, v28, v6
    v_add_f32 v29, v29, v6
    v_add_f32 v30, v30, v6
    v_add_f32 v31, v31, v6
    v_cvt_pk_bf16_f32 v32, v28, v29
    v_cvt_pk_bf16_f32 v33, v30, v31
    v_lshlrev_b32 v28, 16, v32
    v_and_b32 v29, 0xffff0000, v32
    v_lshlrev_b32 v30, 16, v33
    v_and_b32 v31, 0xffff0000, v33
    v_lshlrev_b32 v34, 16, v108
    v_and_b32 v35, 0xffff0000, v108
    v_lshlrev_b32 v36, 16, v109
    v_and_b32 v37, 0xffff0000, v109
    v_mul_f32 v28, v28, v34
    v_mul_f32 v29, v29, v35
    v_mul_f32 v30, v30, v36
    v_mul_f32 v31, v31, v37
    v_cvt_pk_bf16_f32 v38, v28, v29
    v_cvt_pk_bf16_f32 v39, v30, v31
    s_mov_b32 s13, 0
    buffer_store_dwordx2 v[38:39], v5, s[44:47], s13 offen offset:0
    v_cvt_pk_bf16_f32 v32, v80, v81
    v_cvt_pk_bf16_f32 v33, v82, v83
    v_lshlrev_b32 v28, 16, v32
    v_and_b32 v29, 0xffff0000, v32
    v_lshlrev_b32 v30, 16, v33
    v_and_b32 v31, 0xffff0000, v33
    v_add_f32 v28, v28, v7
    v_add_f32 v29, v29, v7
    v_add_f32 v30, v30, v7
    v_add_f32 v31, v31, v7
    v_cvt_pk_bf16_f32 v32, v28, v29
    v_cvt_pk_bf16_f32 v33, v30, v31
    v_lshlrev_b32 v28, 16, v32
    v_and_b32 v29, 0xffff0000, v32
    v_lshlrev_b32 v30, 16, v33
    v_and_b32 v31, 0xffff0000, v33
    v_lshlrev_b32 v34, 16, v110
    v_and_b32 v35, 0xffff0000, v110
    v_lshlrev_b32 v36, 16, v111
    v_and_b32 v37, 0xffff0000, v111
    v_mul_f32 v28, v28, v34
    v_mul_f32 v29, v29, v35
    v_mul_f32 v30, v30, v36
    v_mul_f32 v31, v31, v37
    v_cvt_pk_bf16_f32 v40, v28, v29
    v_cvt_pk_bf16_f32 v41, v30, v31
    s_mov_b32 s13, 28672
    buffer_store_dwordx2 v[40:41], v5, s[44:47], s13 offen offset:0
    v_cvt_pk_bf16_f32 v32, v84, v85
    v_cvt_pk_bf16_f32 v33, v86, v87
    v_lshlrev_b32 v28, 16, v32
    v_and_b32 v29, 0xffff0000, v32
    v_lshlrev_b32 v30, 16, v33
    v_and_b32 v31, 0xffff0000, v33
    v_add_f32 v28, v28, v8
    v_add_f32 v29, v29, v8
    v_add_f32 v30, v30, v8
    v_add_f32 v31, v31, v8
    v_cvt_pk_bf16_f32 v32, v28, v29
    v_cvt_pk_bf16_f32 v33, v30, v31
    v_lshlrev_b32 v28, 16, v32
    v_and_b32 v29, 0xffff0000, v32
    v_lshlrev_b32 v30, 16, v33
    v_and_b32 v31, 0xffff0000, v33
    v_lshlrev_b32 v34, 16, v112
    v_and_b32 v35, 0xffff0000, v112
    v_lshlrev_b32 v36, 16, v113
    v_and_b32 v37, 0xffff0000, v113
    v_mul_f32 v28, v28, v34
    v_mul_f32 v29, v29, v35
    v_mul_f32 v30, v30, v36
    v_mul_f32 v31, v31, v37
    v_cvt_pk_bf16_f32 v42, v28, v29
    v_cvt_pk_bf16_f32 v43, v30, v31
    s_mov_b32 s13, 57344
    buffer_store_dwordx2 v[42:43], v5, s[44:47], s13 offen offset:0
    v_cvt_pk_bf16_f32 v32, v88, v89
    v_cvt_pk_bf16_f32 v33, v90, v91
    v_lshlrev_b32 v28, 16, v32
    v_and_b32 v29, 0xffff0000, v32
    v_lshlrev_b32 v30, 16, v33
    v_and_b32 v31, 0xffff0000, v33
    v_add_f32 v28, v28, v9
    v_add_f32 v29, v29, v9
    v_add_f32 v30, v30, v9
    v_add_f32 v31, v31, v9
    v_cvt_pk_bf16_f32 v32, v28, v29
    v_cvt_pk_bf16_f32 v33, v30, v31
    v_lshlrev_b32 v28, 16, v32
    v_and_b32 v29, 0xffff0000, v32
    v_lshlrev_b32 v30, 16, v33
    v_and_b32 v31, 0xffff0000, v33
    v_lshlrev_b32 v34, 16, v114
    v_and_b32 v35, 0xffff0000, v114
    v_lshlrev_b32 v36, 16, v115
    v_and_b32 v37, 0xffff0000, v115
    v_mul_f32 v28, v28, v34
    v_mul_f32 v29, v29, v35
    v_mul_f32 v30, v30, v36
    v_mul_f32 v31, v31, v37
    v_cvt_pk_bf16_f32 v44, v28, v29
    v_cvt_pk_bf16_f32 v45, v30, v31
    s_mov_b32 s13, 86016
    buffer_store_dwordx2 v[44:45], v5, s[44:47], s13 offen offset:0
    s_endpgm
k3_loader:
    s_sub_u32 s10, s8, 4
    s_lshl_b32 s11, s5, 6
    s_lshl_b32 s12, s10, 4
    s_add_u32 s11, s11, s12
    v_lshrrev_b32 v8, 3, v0
    v_add_u32 v8, 0, v8
    v_add_u32 v8, s11, v8
    v_lshlrev_b32 v8, 12, v8
    v_add_u32 v9, 0, v2
    v_and_b32 v10, 7, v0
    v_xor_b32 v9, v9, v10
    v_lshl_add_u32 v4, v9, 4, v8
    v_lshrrev_b32 v8, 3, v0
    v_add_u32 v8, 8, v8
    v_add_u32 v8, s11, v8
    v_lshlrev_b32 v8, 12, v8
    v_add_u32 v9, 4, v2
    v_and_b32 v10, 7, v0
    v_xor_b32 v9, v9, v10
    v_lshl_add_u32 v5, v9, 4, v8
    s_lshl_b32 s12, s9, 16
    v_lshl_add_u32 v6, v0, 4, s12
    s_waitcnt lgkmcnt(0)
    s_mov_b32 s32, s20
    s_and_b32 s33, s21, 0xffff
    s_mov_b32 s34, 0x800000
    s_mov_b32 s35, 0x00020000
    s_add_u32 s36, s30, 0x800000
    s_addc_u32 s37, s31, 0
    s_and_b32 s37, s37, 0xffff
    s_mov_b32 s38, 0x380000
    s_mov_b32 s39, 0x00020000
    s_cmp_eq_u32 s10, 1
    s_cbranch_scc1 k3_ld1
    s_cmp_eq_u32 s10, 2
    s_cbranch_scc1 k3_ld2
    s_cmp_eq_u32 s10, 3
    s_cbranch_scc1 k3_ld3
    s_mov_b32 s50, 0
    s_mov_b32 s52, 0
    s_mov_b32 s93, 0
    s_add_u32 m0, s93, 0
    s_nop 0
    buffer_load_dwordx4 v4, s[32:35], s50 offen lds
    s_add_u32 m0, s93, 1024
    s_nop 0
    buffer_load_dwordx4 v5, s[32:35], s50 offen lds
    s_add_u32 s51, s52, 0
    s_add_u32 m0, s93, 8192
    s_nop 0
    buffer_load_dwordx4 v6, s[36:39], s51 offen lds
    s_add_u32 s51, s52, 1024
    s_add_u32 m0, s93, 9216
    s_nop 0
    buffer_load_dwordx4 v6, s[36:39], s51 offen lds
    s_add_u32 s51, s52, 65536
    s_add_u32 m0, s93, 10240
    s_nop 0
    buffer_load_dwordx4 v6, s[36:39], s51 offen lds
    s_add_u32 s51, s52, 66560
    s_add_u32 m0, s93, 11264
    s_nop 0
    buffer_load_dwordx4 v6, s[36:39], s51 offen lds
    s_add_u32 s50, s50, 128
    s_add_u32 s52, s52, 2048
    s_add_u32 s93, s93, 22528
    s_cmp_ge_u32 s93, 157696
    s_cselect_b32 s93, 0, s93
    s_add_u32 m0, s93, 0
    s_nop 0
    buffer_load_dwordx4 v4, s[32:35], s50 offen lds
    s_add_u32 m0, s93, 1024
    s_nop 0
    buffer_load_dwordx4 v5, s[32:35], s50 offen lds
    s_add_u32 s51, s52, 0
    s_add_u32 m0, s93, 8192
    s_nop 0
    buffer_load_dwordx4 v6, s[36:39], s51 offen lds
    s_add_u32 s51, s52, 1024
    s_add_u32 m0, s93, 9216
    s_nop 0
    buffer_load_dwordx4 v6, s[36:39], s51 offen lds
    s_add_u32 s51, s52, 65536
    s_add_u32 m0, s93, 10240
    s_nop 0
    buffer_load_dwordx4 v6, s[36:39], s51 offen lds
    s_add_u32 s51, s52, 66560
    s_add_u32 m0, s93, 11264
    s_nop 0
    buffer_load_dwordx4 v6, s[36:39], s51 offen lds
    s_add_u32 s50, s50, 128
    s_add_u32 s52, s52, 2048
    s_add_u32 s93, s93, 22528
    s_cmp_ge_u32 s93, 157696
    s_cselect_b32 s93, 0, s93
    s_add_u32 m0, s93, 0
    s_nop 0
    buffer_load_dwordx4 v4, s[32:35], s50 offen lds
    s_add_u32 m0, s93, 1024
    s_nop 0
    buffer_load_dwordx4 v5, s[32:35], s50 offen lds
    s_add_u32 s51, s52, 0
    s_add_u32 m0, s93, 8192
    s_nop 0
    buffer_load_dwordx4 v6, s[36:39], s51 offen lds
    s_add_u32 s51, s52, 1024
    s_add_u32 m0, s93, 9216
    s_nop 0
    buffer_load_dwordx4 v6, s[36:39], s51 offen lds
    s_add_u32 s51, s52, 65536
    s_add_u32 m0, s93, 10240
    s_nop 0
    buffer_load_dwordx4 v6, s[36:39], s51 offen lds
    s_add_u32 s51, s52, 66560
    s_add_u32 m0, s93, 11264
    s_nop 0
    buffer_load_dwordx4 v6, s[36:39], s51 offen lds
    s_add_u32 s50, s50, 128
    s_add_u32 s52, s52, 2048
    s_add_u32 s93, s93, 22528
    s_cmp_ge_u32 s93, 157696
    s_cselect_b32 s93, 0, s93
    s_waitcnt vmcnt(12)
    s_barrier
    s_add_u32 m0, s93, 0
    s_nop 0
    buffer_load_dwordx4 v4, s[32:35], s50 offen lds
    s_add_u32 m0, s93, 1024
    s_nop 0
    buffer_load_dwordx4 v5, s[32:35], s50 offen lds
    s_add_u32 s51, s52, 0
    s_add_u32 m0, s93, 8192
    s_nop 0
    buffer_load_dwordx4 v6, s[36:39], s51 offen lds
    s_add_u32 s51, s52, 1024
    s_add_u32 m0, s93, 9216
    s_nop 0
    buffer_load_dwordx4 v6, s[36:39], s51 offen lds
    s_add_u32 s51, s52, 65536
    s_add_u32 m0, s93, 10240
    s_nop 0
    buffer_load_dwordx4 v6, s[36:39], s51 offen lds
    s_add_u32 s51, s52, 66560
    s_add_u32 m0, s93, 11264
    s_nop 0
    buffer_load_dwordx4 v6, s[36:39], s51 offen lds
    s_add_u32 s50, s50, 128
    s_add_u32 s52, s52, 2048
    s_add_u32 s93, s93, 22528
    s_cmp_ge_u32 s93, 157696
    s_cselect_b32 s93, 0, s93
    s_add_u32 m0, s93, 0
    s_nop 0
    buffer_load_dwordx4 v4, s[32:35], s50 offen lds
    s_add_u32 m0, s93, 1024
    s_nop 0
    buffer_load_dwordx4 v5, s[32:35], s50 offen lds
    s_add_u32 s51, s52, 0
    s_add_u32 m0, s93, 8192
    s_nop 0
    buffer_load_dwordx4 v6, s[36:39], s51 offen lds
    s_add_u32 s51, s52, 1024
    s_add_u32 m0, s93, 9216
    s_nop 0
    buffer_load_dwordx4 v6, s[36:39], s51 offen lds
    s_add_u32 s51, s52, 65536
    s_add_u32 m0, s93, 10240
    s_nop 0
    buffer_load_dwordx4 v6, s[36:39], s51 offen lds
    s_add_u32 s51, s52, 66560
    s_add_u32 m0, s93, 11264
    s_nop 0
    buffer_load_dwordx4 v6, s[36:39], s51 offen lds
    s_add_u32 s50, s50, 128
    s_add_u32 s52, s52, 2048
    s_add_u32 s93, s93, 22528
    s_cmp_ge_u32 s93, 157696
    s_cselect_b32 s93, 0, s93
    s_waitcnt vmcnt(18)
    s_barrier
    s_add_u32 m0, s93, 0
    s_nop 0
    buffer_load_dwordx4 v4, s[32:35], s50 offen lds
    s_add_u32 m0, s93, 1024
    s_nop 0
    buffer_load_dwordx4 v5, s[32:35], s50 offen lds
    s_add_u32 s51, s52, 0
    s_add_u32 m0, s93, 8192
    s_nop 0
    buffer_load_dwordx4 v6, s[36:39], s51 offen lds
    s_add_u32 s51, s52, 1024
    s_add_u32 m0, s93, 9216
    s_nop 0
    buffer_load_dwordx4 v6, s[36:39], s51 offen lds
    s_add_u32 s51, s52, 65536
    s_add_u32 m0, s93, 10240
    s_nop 0
    buffer_load_dwordx4 v6, s[36:39], s51 offen lds
    s_add_u32 s51, s52, 66560
    s_add_u32 m0, s93, 11264
    s_nop 0
    buffer_load_dwordx4 v6, s[36:39], s51 offen lds
    s_add_u32 s50, s50, 128
    s_add_u32 s52, s52, 2048
    s_add_u32 s93, s93, 22528
    s_cmp_ge_u32 s93, 157696
    s_cselect_b32 s93, 0, s93
    s_add_u32 m0, s93, 0
    s_nop 0
    buffer_load_dwordx4 v4, s[32:35], s50 offen lds
    s_add_u32 m0, s93, 1024
    s_nop 0
    buffer_load_dwordx4 v5, s[32:35], s50 offen lds
    s_add_u32 s51, s52, 0
    s_add_u32 m0, s93, 8192
    s_nop 0
    buffer_load_dwordx4 v6, s[36:39], s51 offen lds
    s_add_u32 s51, s52, 1024
    s_add_u32 m0, s93, 9216
    s_nop 0
    buffer_load_dwordx4 v6, s[36:39], s51 offen lds
    s_add_u32 s51, s52, 65536
    s_add_u32 m0, s93, 10240
    s_nop 0
    buffer_load_dwordx4 v6, s[36:39], s51 offen lds
    s_add_u32 s51, s52, 66560
    s_add_u32 m0, s93, 11264
    s_nop 0
    buffer_load_dwordx4 v6, s[36:39], s51 offen lds
    s_add_u32 s50, s50, 128
    s_add_u32 s52, s52, 2048
    s_add_u32 s93, s93, 22528
    s_cmp_ge_u32 s93, 157696
    s_cselect_b32 s93, 0, s93
    s_waitcnt vmcnt(24)
    s_barrier
    s_add_u32 m0, s93, 0
    s_nop 0
    buffer_load_dwordx4 v4, s[32:35], s50 offen lds
    s_add_u32 m0, s93, 1024
    s_nop 0
    buffer_load_dwordx4 v5, s[32:35], s50 offen lds
    s_add_u32 s51, s52, 0
    s_add_u32 m0, s93, 8192
    s_nop 0
    buffer_load_dwordx4 v6, s[36:39], s51 offen lds
    s_add_u32 s51, s52, 1024
    s_add_u32 m0, s93, 9216
    s_nop 0
    buffer_load_dwordx4 v6, s[36:39], s51 offen lds
    s_add_u32 s51, s52, 65536
    s_add_u32 m0, s93, 10240
    s_nop 0
    buffer_load_dwordx4 v6, s[36:39], s51 offen lds
    s_add_u32 s51, s52, 66560
    s_add_u32 m0, s93, 11264
    s_nop 0
    buffer_load_dwordx4 v6, s[36:39], s51 offen lds
    s_add_u32 s50, s50, 128
    s_add_u32 s52, s52, 2048
    s_add_u32 s93, s93, 22528
    s_cmp_ge_u32 s93, 157696
    s_cselect_b32 s93, 0, s93
    s_add_u32 m0, s93, 0
    s_nop 0
    buffer_load_dwordx4 v4, s[32:35], s50 offen lds
    s_add_u32 m0, s93, 1024
    s_nop 0
    buffer_load_dwordx4 v5, s[32:35], s50 offen lds
    s_add_u32 s51, s52, 0
    s_add_u32 m0, s93, 8192
    s_nop 0
    buffer_load_dwordx4 v6, s[36:39], s51 offen lds
    s_add_u32 s51, s52, 1024
    s_add_u32 m0, s93, 9216
    s_nop 0
    buffer_load_dwordx4 v6, s[36:39], s51 offen lds
    s_add_u32 s51, s52, 65536
    s_add_u32 m0, s93, 10240
    s_nop 0
    buffer_load_dwordx4 v6, s[36:39], s51 offen lds
    s_add_u32 s51, s52, 66560
    s_add_u32 m0, s93, 11264
    s_nop 0
    buffer_load_dwordx4 v6, s[36:39], s51 offen lds
    s_add_u32 s50, s50, 128
    s_add_u32 s52, s52, 2048
    s_add_u32 s93, s93, 22528
    s_cmp_ge_u32 s93, 157696
    s_cselect_b32 s93, 0, s93
    s_movk_i32 s92, 23
ldl6:
    s_waitcnt vmcnt(30)
    s_barrier
    s_add_u32 m0, s93, 0
    s_nop 0
    buffer_load_dwordx4 v4, s[32:35], s50 offen lds
    s_add_u32 m0, s93, 1024
    s_nop 0
    buffer_load_dwordx4 v5, s[32:35], s50 offen lds
    s_add_u32 s51, s52, 0
    s_add_u32 m0, s93, 8192
    s_nop 0
    buffer_load_dwordx4 v6, s[36:39], s51 offen lds
    s_add_u32 s51, s52, 1024
    s_add_u32 m0, s93, 9216
    s_nop 0
    buffer_load_dwordx4 v6, s[36:39], s51 offen lds
    s_add_u32 s51, s52, 65536
    s_add_u32 m0, s93, 10240
    s_nop 0
    buffer_load_dwordx4 v6, s[36:39], s51 offen lds
    s_add_u32 s51, s52, 66560
    s_add_u32 m0, s93, 11264
    s_nop 0
    buffer_load_dwordx4 v6, s[36:39], s51 offen lds
    s_add_u32 s50, s50, 128
    s_add_u32 s52, s52, 2048
    s_add_u32 s93, s93, 22528
    s_cmp_ge_u32 s93, 157696
    s_cselect_b32 s93, 0, s93
    s_sub_u32 s92, s92, 1
    s_cmp_lg_u32 s92, 0
    s_cbranch_scc1 ldl6
    s_waitcnt vmcnt(30)
    s_barrier
    s_waitcnt vmcnt(24)
    s_barrier
    s_waitcnt vmcnt(18)
    s_barrier
    s_waitcnt vmcnt(12)
    s_barrier
    s_waitcnt vmcnt(6)
    s_barrier
    s_waitcnt vmcnt(0)
    s_barrier
    s_endpgm
k3_ld1:
    s_mov_b32 s50, 0
    s_mov_b32 s52, 0
    s_mov_b32 s93, 0
    s_add_u32 m0, s93, 2048
    s_nop 0
    buffer_load_dwordx4 v4, s[32:35], s50 offen lds
    s_add_u32 m0, s93, 3072
    s_nop 0
    buffer_load_dwordx4 v5, s[32:35], s50 offen lds
    s_add_u32 s51, s52, 131072
    s_add_u32 m0, s93, 12288
    s_nop 0
    buffer_load_dwordx4 v6, s[36:39], s51 offen lds
    s_add_u32 s51, s52, 132096
    s_add_u32 m0, s93, 13312
    s_nop 0
    buffer_load_dwordx4 v6, s[36:39], s51 offen lds
    s_add_u32 s51, s52, 196608
    s_add_u32 m0, s93, 14336
    s_nop 0
    buffer_load_dwordx4 v6, s[36:39], s51 offen lds
    s_add_u32 s51, s52, 197632
    s_add_u32 m0, s93, 15360
    s_nop 0
    buffer_load_dwordx4 v6, s[36:39], s51 offen lds
    s_add_u32 s50, s50, 128
    s_add_u32 s52, s52, 2048
    s_add_u32 s93, s93, 22528
    s_cmp_ge_u32 s93, 157696
    s_cselect_b32 s93, 0, s93
    s_add_u32 m0, s93, 2048
    s_nop 0
    buffer_load_dwordx4 v4, s[32:35], s50 offen lds
    s_add_u32 m0, s93, 3072
    s_nop 0
    buffer_load_dwordx4 v5, s[32:35], s50 offen lds
    s_add_u32 s51, s52, 131072
    s_add_u32 m0, s93, 12288
    s_nop 0
    buffer_load_dwordx4 v6, s[36:39], s51 offen lds
    s_add_u32 s51, s52, 132096
    s_add_u32 m0, s93, 13312
    s_nop 0
    buffer_load_dwordx4 v6, s[36:39], s51 offen lds
    s_add_u32 s51, s52, 196608
    s_add_u32 m0, s93, 14336
    s_nop 0
    buffer_load_dwordx4 v6, s[36:39], s51 offen lds
    s_add_u32 s51, s52, 197632
    s_add_u32 m0, s93, 15360
    s_nop 0
    buffer_load_dwordx4 v6, s[36:39], s51 offen lds
    s_add_u32 s50, s50, 128
    s_add_u32 s52, s52, 2048
    s_add_u32 s93, s93, 22528
    s_cmp_ge_u32 s93, 157696
    s_cselect_b32 s93, 0, s93
    s_add_u32 m0, s93, 2048
    s_nop 0
    buffer_load_dwordx4 v4, s[32:35], s50 offen lds
    s_add_u32 m0, s93, 3072
    s_nop 0
    buffer_load_dwordx4 v5, s[32:35], s50 offen lds
    s_add_u32 s51, s52, 131072
    s_add_u32 m0, s93, 12288
    s_nop 0
    buffer_load_dwordx4 v6, s[36:39], s51 offen lds
    s_add_u32 s51, s52, 132096
    s_add_u32 m0, s93, 13312
    s_nop 0
    buffer_load_dwordx4 v6, s[36:39], s51 offen lds
    s_add_u32 s51, s52, 196608
    s_add_u32 m0, s93, 14336
    s_nop 0
    buffer_load_dwordx4 v6, s[36:39], s51 offen lds
    s_add_u32 s51, s52, 197632
    s_add_u32 m0, s93, 15360
    s_nop 0
    buffer_load_dwordx4 v6, s[36:39], s51 offen lds
    s_add_u32 s50, s50, 128
    s_add_u32 s52, s52, 2048
    s_add_u32 s93, s93, 22528
    s_cmp_ge_u32 s93, 157696
    s_cselect_b32 s93, 0, s93
    s_waitcnt vmcnt(12)
    s_barrier
    s_add_u32 m0, s93, 2048
    s_nop 0
    buffer_load_dwordx4 v4, s[32:35], s50 offen lds
    s_add_u32 m0, s93, 3072
    s_nop 0
    buffer_load_dwordx4 v5, s[32:35], s50 offen lds
    s_add_u32 s51, s52, 131072
    s_add_u32 m0, s93, 12288
    s_nop 0
    buffer_load_dwordx4 v6, s[36:39], s51 offen lds
    s_add_u32 s51, s52, 132096
    s_add_u32 m0, s93, 13312
    s_nop 0
    buffer_load_dwordx4 v6, s[36:39], s51 offen lds
    s_add_u32 s51, s52, 196608
    s_add_u32 m0, s93, 14336
    s_nop 0
    buffer_load_dwordx4 v6, s[36:39], s51 offen lds
    s_add_u32 s51, s52, 197632
    s_add_u32 m0, s93, 15360
    s_nop 0
    buffer_load_dwordx4 v6, s[36:39], s51 offen lds
    s_add_u32 s50, s50, 128
    s_add_u32 s52, s52, 2048
    s_add_u32 s93, s93, 22528
    s_cmp_ge_u32 s93, 157696
    s_cselect_b32 s93, 0, s93
    s_add_u32 m0, s93, 2048
    s_nop 0
    buffer_load_dwordx4 v4, s[32:35], s50 offen lds
    s_add_u32 m0, s93, 3072
    s_nop 0
    buffer_load_dwordx4 v5, s[32:35], s50 offen lds
    s_add_u32 s51, s52, 131072
    s_add_u32 m0, s93, 12288
    s_nop 0
    buffer_load_dwordx4 v6, s[36:39], s51 offen lds
    s_add_u32 s51, s52, 132096
    s_add_u32 m0, s93, 13312
    s_nop 0
    buffer_load_dwordx4 v6, s[36:39], s51 offen lds
    s_add_u32 s51, s52, 196608
    s_add_u32 m0, s93, 14336
    s_nop 0
    buffer_load_dwordx4 v6, s[36:39], s51 offen lds
    s_add_u32 s51, s52, 197632
    s_add_u32 m0, s93, 15360
    s_nop 0
    buffer_load_dwordx4 v6, s[36:39], s51 offen lds
    s_add_u32 s50, s50, 128
    s_add_u32 s52, s52, 2048
    s_add_u32 s93, s93, 22528
    s_cmp_ge_u32 s93, 157696
    s_cselect_b32 s93, 0, s93
    s_waitcnt vmcnt(18)
    s_barrier
    s_add_u32 m0, s93, 2048
    s_nop 0
    buffer_load_dwordx4 v4, s[32:35], s50 offen lds
    s_add_u32 m0, s93, 3072
    s_nop 0
    buffer_load_dwordx4 v5, s[32:35], s50 offen lds
    s_add_u32 s51, s52, 131072
    s_add_u32 m0, s93, 12288
    s_nop 0
    buffer_load_dwordx4 v6, s[36:39], s51 offen lds
    s_add_u32 s51, s52, 132096
    s_add_u32 m0, s93, 13312
    s_nop 0
    buffer_load_dwordx4 v6, s[36:39], s51 offen lds
    s_add_u32 s51, s52, 196608
    s_add_u32 m0, s93, 14336
    s_nop 0
    buffer_load_dwordx4 v6, s[36:39], s51 offen lds
    s_add_u32 s51, s52, 197632
    s_add_u32 m0, s93, 15360
    s_nop 0
    buffer_load_dwordx4 v6, s[36:39], s51 offen lds
    s_add_u32 s50, s50, 128
    s_add_u32 s52, s52, 2048
    s_add_u32 s93, s93, 22528
    s_cmp_ge_u32 s93, 157696
    s_cselect_b32 s93, 0, s93
    s_add_u32 m0, s93, 2048
    s_nop 0
    buffer_load_dwordx4 v4, s[32:35], s50 offen lds
    s_add_u32 m0, s93, 3072
    s_nop 0
    buffer_load_dwordx4 v5, s[32:35], s50 offen lds
    s_add_u32 s51, s52, 131072
    s_add_u32 m0, s93, 12288
    s_nop 0
    buffer_load_dwordx4 v6, s[36:39], s51 offen lds
    s_add_u32 s51, s52, 132096
    s_add_u32 m0, s93, 13312
    s_nop 0
    buffer_load_dwordx4 v6, s[36:39], s51 offen lds
    s_add_u32 s51, s52, 196608
    s_add_u32 m0, s93, 14336
    s_nop 0
    buffer_load_dwordx4 v6, s[36:39], s51 offen lds
    s_add_u32 s51, s52, 197632
    s_add_u32 m0, s93, 15360
    s_nop 0
    buffer_load_dwordx4 v6, s[36:39], s51 offen lds
    s_add_u32 s50, s50, 128
    s_add_u32 s52, s52, 2048
    s_add_u32 s93, s93, 22528
    s_cmp_ge_u32 s93, 157696
    s_cselect_b32 s93, 0, s93
    s_waitcnt vmcnt(24)
    s_barrier
    s_add_u32 m0, s93, 2048
    s_nop 0
    buffer_load_dwordx4 v4, s[32:35], s50 offen lds
    s_add_u32 m0, s93, 3072
    s_nop 0
    buffer_load_dwordx4 v5, s[32:35], s50 offen lds
    s_add_u32 s51, s52, 131072
    s_add_u32 m0, s93, 12288
    s_nop 0
    buffer_load_dwordx4 v6, s[36:39], s51 offen lds
    s_add_u32 s51, s52, 132096
    s_add_u32 m0, s93, 13312
    s_nop 0
    buffer_load_dwordx4 v6, s[36:39], s51 offen lds
    s_add_u32 s51, s52, 196608
    s_add_u32 m0, s93, 14336
    s_nop 0
    buffer_load_dwordx4 v6, s[36:39], s51 offen lds
    s_add_u32 s51, s52, 197632
    s_add_u32 m0, s93, 15360
    s_nop 0
    buffer_load_dwordx4 v6, s[36:39], s51 offen lds
    s_add_u32 s50, s50, 128
    s_add_u32 s52, s52, 2048
    s_add_u32 s93, s93, 22528
    s_cmp_ge_u32 s93, 157696
    s_cselect_b32 s93, 0, s93
    s_add_u32 m0, s93, 2048
    s_nop 0
    buffer_load_dwordx4 v4, s[32:35], s50 offen lds
    s_add_u32 m0, s93, 3072
    s_nop 0
    buffer_load_dwordx4 v5, s[32:35], s50 offen lds
    s_add_u32 s51, s52, 131072
    s_add_u32 m0, s93, 12288
    s_nop 0
    buffer_load_dwordx4 v6, s[36:39], s51 offen lds
    s_add_u32 s51, s52, 132096
    s_add_u32 m0, s93, 13312
    s_nop 0
    buffer_load_dwordx4 v6, s[36:39], s51 offen lds
    s_add_u32 s51, s52, 196608
    s_add_u32 m0, s93, 14336
    s_nop 0
    buffer_load_dwordx4 v6, s[36:39], s51 offen lds
    s_add_u32 s51, s52, 197632
    s_add_u32 m0, s93, 15360
    s_nop 0
    buffer_load_dwordx4 v6, s[36:39], s51 offen lds
    s_add_u32 s50, s50, 128
    s_add_u32 s52, s52, 2048
    s_add_u32 s93, s93, 22528
    s_cmp_ge_u32 s93, 157696
    s_cselect_b32 s93, 0, s93
    s_movk_i32 s92, 23
ldl7:
    s_waitcnt vmcnt(30)
    s_barrier
    s_add_u32 m0, s93, 2048
    s_nop 0
    buffer_load_dwordx4 v4, s[32:35], s50 offen lds
    s_add_u32 m0, s93, 3072
    s_nop 0
    buffer_load_dwordx4 v5, s[32:35], s50 offen lds
    s_add_u32 s51, s52, 131072
    s_add_u32 m0, s93, 12288
    s_nop 0
    buffer_load_dwordx4 v6, s[36:39], s51 offen lds
    s_add_u32 s51, s52, 132096
    s_add_u32 m0, s93, 13312
    s_nop 0
    buffer_load_dwordx4 v6, s[36:39], s51 offen lds
    s_add_u32 s51, s52, 196608
    s_add_u32 m0, s93, 14336
    s_nop 0
    buffer_load_dwordx4 v6, s[36:39], s51 offen lds
    s_add_u32 s51, s52, 197632
    s_add_u32 m0, s93, 15360
    s_nop 0
    buffer_load_dwordx4 v6, s[36:39], s51 offen lds
    s_add_u32 s50, s50, 128
    s_add_u32 s52, s52, 2048
    s_add_u32 s93, s93, 22528
    s_cmp_ge_u32 s93, 157696
    s_cselect_b32 s93, 0, s93
    s_sub_u32 s92, s92, 1
    s_cmp_lg_u32 s92, 0
    s_cbranch_scc1 ldl7
    s_waitcnt vmcnt(30)
    s_barrier
    s_waitcnt vmcnt(24)
    s_barrier
    s_waitcnt vmcnt(18)
    s_barrier
    s_waitcnt vmcnt(12)
    s_barrier
    s_waitcnt vmcnt(6)
    s_barrier
    s_waitcnt vmcnt(0)
    s_barrier
    s_endpgm
k3_ld2:
    s_mov_b32 s50, 0
    s_mov_b32 s52, 0
    s_mov_b32 s93, 0
    s_add_u32 m0, s93, 4096
    s_nop 0
    buffer_load_dwordx4 v4, s[32:35], s50 offen lds
    s_add_u32 m0, s93, 5120
    s_nop 0
    buffer_load_dwordx4 v5, s[32:35], s50 offen lds
    s_add_u32 s51, s52, 262144
    s_add_u32 m0, s93, 16384
    s_nop 0
    buffer_load_dwordx4 v6, s[36:39], s51 offen lds
    s_add_u32 s51, s52, 263168
    s_add_u32 m0, s93, 17408
    s_nop 0
    buffer_load_dwordx4 v6, s[36:39], s51 offen lds
    s_add_u32 s51, s52, 327680
    s_add_u32 m0, s93, 18432
    s_nop 0
    buffer_load_dwordx4 v6, s[36:39], s51 offen lds
    s_add_u32 s50, s50, 128
    s_add_u32 s52, s52, 2048
    s_add_u32 s93, s93, 22528
    s_cmp_ge_u32 s93, 157696
    s_cselect_b32 s93, 0, s93
    s_add_u32 m0, s93, 4096
    s_nop 0
    buffer_load_dwordx4 v4, s[32:35], s50 offen lds
    s_add_u32 m0, s93, 5120
    s_nop 0
    buffer_load_dwordx4 v5, s[32:35], s50 offen lds
    s_add_u32 s51, s52, 262144
    s_add_u32 m0, s93, 16384
    s_nop 0
    buffer_load_dwordx4 v6, s[36:39], s51 offen lds
    s_add_u32 s51, s52, 263168
    s_add_u32 m0, s93, 17408
    s_nop 0
    buffer_load_dwordx4 v6, s[36:39], s51 offen lds
    s_add_u32 s51, s52, 327680
    s_add_u32 m0, s93, 18432
    s_nop 0
    buffer_load_dwordx4 v6, s[36:39], s51 offen lds
    s_add_u32 s50, s50, 128
    s_add_u32 s52, s52, 2048
    s_add_u32 s93, s93, 22528
    s_cmp_ge_u32 s93, 157696
    s_cselect_b32 s93, 0, s93
    s_add_u32 m0, s93, 4096
    s_nop 0
    buffer_load_dwordx4 v4, s[32:35], s50 offen lds
    s_add_u32 m0, s93, 5120
    s_nop 0
    buffer_load_dwordx4 v5, s[32:35], s50 offen lds
    s_add_u32 s51, s52, 262144
    s_add_u32 m0, s93, 16384
    s_nop 0
    buffer_load_dwordx4 v6, s[36:39], s51 offen lds
    s_add_u32 s51, s52, 263168
    s_add_u32 m0, s93, 17408
    s_nop 0
    buffer_load_dwordx4 v6, s[36:39], s51 offen lds
    s_add_u32 s51, s52, 327680
    s_add_u32 m0, s93, 18432
    s_nop 0
    buffer_load_dwordx4 v6, s[36:39], s51 offen lds
    s_add_u32 s50, s50, 128
    s_add_u32 s52, s52, 2048
    s_add_u32 s93, s93, 22528
    s_cmp_ge_u32 s93, 157696
    s_cselect_b32 s93, 0, s93
    s_waitcnt vmcnt(10)
    s_barrier
    s_add_u32 m0, s93, 4096
    s_nop 0
    buffer_load_dwordx4 v4, s[32:35], s50 offen lds
    s_add_u32 m0, s93, 5120
    s_nop 0
    buffer_load_dwordx4 v5, s[32:35], s50 offen lds
    s_add_u32 s51, s52, 262144
    s_add_u32 m0, s93, 16384
    s_nop 0
    buffer_load_dwordx4 v6, s[36:39], s51 offen lds
    s_add_u32 s51, s52, 263168
    s_add_u32 m0, s93, 17408
    s_nop 0
    buffer_load_dwordx4 v6, s[36:39], s51 offen lds
    s_add_u32 s51, s52, 327680
    s_add_u32 m0, s93, 18432
    s_nop 0
    buffer_load_dwordx4 v6, s[36:39], s51 offen lds
    s_add_u32 s50, s50, 128
    s_add_u32 s52, s52, 2048
    s_add_u32 s93, s93, 22528
    s_cmp_ge_u32 s93, 157696
    s_cselect_b32 s93, 0, s93
    s_add_u32 m0, s93, 4096
    s_nop 0
    buffer_load_dwordx4 v4, s[32:35], s50 offen lds
    s_add_u32 m0, s93, 5120
    s_nop 0
    buffer_load_dwordx4 v5, s[32:35], s50 offen lds
    s_add_u32 s51, s52, 262144
    s_add_u32 m0, s93, 16384
    s_nop 0
    buffer_load_dwordx4 v6, s[36:39], s51 offen lds
    s_add_u32 s51, s52, 263168
    s_add_u32 m0, s93, 17408
    s_nop 0
    buffer_load_dwordx4 v6, s[36:39], s51 offen lds
    s_add_u32 s51, s52, 327680
    s_add_u32 m0, s93, 18432
    s_nop 0
    buffer_load_dwordx4 v6, s[36:39], s51 offen lds
    s_add_u32 s50, s50, 128
    s_add_u32 s52, s52, 2048
    s_add_u32 s93, s93, 22528
    s_cmp_ge_u32 s93, 157696
    s_cselect_b32 s93, 0, s93
    s_waitcnt vmcnt(15)
    s_barrier
    s_add_u32 m0, s93, 4096
    s_nop 0
    buffer_load_dwordx4 v4, s[32:35], s50 offen lds
    s_add_u32 m0, s93, 5120
    s_nop 0
    buffer_load_dwordx4 v5, s[32:35], s50 offen lds
    s_add_u32 s51, s52, 262144
    s_add_u32 m0, s93, 16384
    s_nop 0
    buffer_load_dwordx4 v6, s[36:39], s51 offen lds
    s_add_u32 s51, s52, 263168
    s_add_u32 m0, s93, 17408
    s_nop 0
    buffer_load_dwordx4 v6, s[36:39], s51 offen lds
    s_add_u32 s51, s52, 327680
    s_add_u32 m0, s93, 18432
    s_nop 0
    buffer_load_dwordx4 v6, s[36:39], s51 offen lds
    s_add_u32 s50, s50, 128
    s_add_u32 s52, s52, 2048
    s_add_u32 s93, s93, 22528
    s_cmp_ge_u32 s93, 157696
    s_cselect_b32 s93, 0, s93
    s_add_u32 m0, s93, 4096
    s_nop 0
    buffer_load_dwordx4 v4, s[32:35], s50 offen lds
    s_add_u32 m0, s93, 5120
    s_nop 0
    buffer_load_dwordx4 v5, s[32:35], s50 offen lds
    s_add_u32 s51, s52, 262144
    s_add_u32 m0, s93, 16384
    s_nop 0
    buffer_load_dwordx4 v6, s[36:39], s51 offen lds
    s_add_u32 s51, s52, 263168
    s_add_u32 m0, s93, 17408
    s_nop 0
    buffer_load_dwordx4 v6, s[36:39], s51 offen lds
    s_add_u32 s51, s52, 327680
    s_add_u32 m0, s93, 18432
    s_nop 0
    buffer_load_dwordx4 v6, s[36:39], s51 offen lds
    s_add_u32 s50, s50, 128
    s_add_u32 s52, s52, 2048
    s_add_u32 s93, s93, 22528
    s_cmp_ge_u32 s93, 157696
    s_cselect_b32 s93, 0, s93
    s_waitcnt vmcnt(20)
    s_barrier
    s_add_u32 m0, s93, 4096
    s_nop 0
    buffer_load_dwordx4 v4, s[32:35], s50 offen lds
    s_add_u32 m0, s93, 5120
    s_nop 0
    buffer_load_dwordx4 v5, s[32:35], s50 offen lds
    s_add_u32 s51, s52, 262144
    s_add_u32 m0, s93, 16384
    s_nop 0
    buffer_load_dwordx4 v6, s[36:39], s51 offen lds
    s_add_u32 s51, s52, 263168
    s_add_u32 m0, s93, 17408
    s_nop 0
    buffer_load_dwordx4 v6, s[36:39], s51 offen lds
    s_add_u32 s51, s52, 327680
    s_add_u32 m0, s93, 18432
    s_nop 0
    buffer_load_dwordx4 v6, s[36:39], s51 offen lds
    s_add_u32 s50, s50, 128
    s_add_u32 s52, s52, 2048
    s_add_u32 s93, s93, 22528
    s_cmp_ge_u32 s93, 157696
    s_cselect_b32 s93, 0, s93
    s_add_u32 m0, s93, 4096
    s_nop 0
    buffer_load_dwordx4 v4, s[32:35], s50 offen lds
    s_add_u32 m0, s93, 5120
    s_nop 0
    buffer_load_dwordx4 v5, s[32:35], s50 offen lds
    s_add_u32 s51, s52, 262144
    s_add_u32 m0, s93, 16384
    s_nop 0
    buffer_load_dwordx4 v6, s[36:39], s51 offen lds
    s_add_u32 s51, s52, 263168
    s_add_u32 m0, s93, 17408
    s_nop 0
    buffer_load_dwordx4 v6, s[36:39], s51 offen lds
    s_add_u32 s51, s52, 327680
    s_add_u32 m0, s93, 18432
    s_nop 0
    buffer_load_dwordx4 v6, s[36:39], s51 offen lds
    s_add_u32 s50, s50, 128
    s_add_u32 s52, s52, 2048
    s_add_u32 s93, s93, 22528
    s_cmp_ge_u32 s93, 157696
    s_cselect_b32 s93, 0, s93
    s_movk_i32 s92, 23
ldl8:
    s_waitcnt vmcnt(25)
    s_barrier
    s_add_u32 m0, s93, 4096
    s_nop 0
    buffer_load_dwordx4 v4, s[32:35], s50 offen lds
    s_add_u32 m0, s93, 5120
    s_nop 0
    buffer_load_dwordx4 v5, s[32:35], s50 offen lds
    s_add_u32 s51, s52, 262144
    s_add_u32 m0, s93, 16384
    s_nop 0
    buffer_load_dwordx4 v6, s[36:39], s51 offen lds
    s_add_u32 s51, s52, 263168
    s_add_u32 m0, s93, 17408
    s_nop 0
    buffer_load_dwordx4 v6, s[36:39], s51 offen lds
    s_add_u32 s51, s52, 327680
    s_add_u32 m0, s93, 18432
    s_nop 0
    buffer_load_dwordx4 v6, s[36:39], s51 offen lds
    s_add_u32 s50, s50, 128
    s_add_u32 s52, s52, 2048
    s_add_u32 s93, s93, 22528
    s_cmp_ge_u32 s93, 157696
    s_cselect_b32 s93, 0, s93
    s_sub_u32 s92, s92, 1
    s_cmp_lg_u32 s92, 0
    s_cbranch_scc1 ldl8
    s_waitcnt vmcnt(25)
    s_barrier
    s_waitcnt vmcnt(20)
    s_barrier
    s_waitcnt vmcnt(15)
    s_barrier
    s_waitcnt vmcnt(10)
    s_barrier
    s_waitcnt vmcnt(5)
    s_barrier
    s_waitcnt vmcnt(0)
    s_barrier
    s_endpgm
k3_ld3:
    s_mov_b32 s50, 0
    s_mov_b32 s52, 0
    s_mov_b32 s93, 0
    s_add_u32 m0, s93, 6144
    s_nop 0
    buffer_load_dwordx4 v4, s[32:35], s50 offen lds
    s_add_u32 m0, s93, 7168
    s_nop 0
    buffer_load_dwordx4 v5, s[32:35], s50 offen lds
    s_add_u32 s51, s52, 328704
    s_add_u32 m0, s93, 19456
    s_nop 0
    buffer_load_dwordx4 v6, s[36:39], s51 offen lds
    s_add_u32 s51, s52, 393216
    s_add_u32 m0, s93, 20480
    s_nop 0
    buffer_load_dwordx4 v6, s[36:39], s51 offen lds
    s_add_u32 s51, s52, 394240
    s_add_u32 m0, s93, 21504
    s_nop 0
    buffer_load_dwordx4 v6, s[36:39], s51 offen lds
    s_add_u32 s50, s50, 128
    s_add_u32 s52, s52, 2048
    s_add_u32 s93, s93, 22528
    s_cmp_ge_u32 s93, 157696
    s_cselect_b32 s93, 0, s93
    s_add_u32 m0, s93, 6144
    s_nop 0
    buffer_load_dwordx4 v4, s[32:35], s50 offen lds
    s_add_u32 m0, s93, 7168
    s_nop 0
    buffer_load_dwordx4 v5, s[32:35], s50 offen lds
    s_add_u32 s51, s52, 328704
    s_add_u32 m0, s93, 19456
    s_nop 0
    buffer_load_dwordx4 v6, s[36:39], s51 offen lds
    s_add_u32 s51, s52, 393216
    s_add_u32 m0, s93, 20480
    s_nop 0
    buffer_load_dwordx4 v6, s[36:39], s51 offen lds
    s_add_u32 s51, s52, 394240
    s_add_u32 m0, s93, 21504
    s_nop 0
    buffer_load_dwordx4 v6, s[36:39], s51 offen lds
    s_add_u32 s50, s50, 128
    s_add_u32 s52, s52, 2048
    s_add_u32 s93, s93, 22528
    s_cmp_ge_u32 s93, 157696
    s_cselect_b32 s93, 0, s93
    s_add_u32 m0, s93, 6144
    s_nop 0
    buffer_load_dwordx4 v4, s[32:35], s50 offen lds
    s_add_u32 m0, s93, 7168
    s_nop 0
    buffer_load_dwordx4 v5, s[32:35], s50 offen lds
    s_add_u32 s51, s52, 328704
    s_add_u32 m0, s93, 19456
    s_nop 0
    buffer_load_dwordx4 v6, s[36:39], s51 offen lds
    s_add_u32 s51, s52, 393216
    s_add_u32 m0, s93, 20480
    s_nop 0
    buffer_load_dwordx4 v6, s[36:39], s51 offen lds
    s_add_u32 s51, s52, 394240
    s_add_u32 m0, s93, 21504
    s_nop 0
    buffer_load_dwordx4 v6, s[36:39], s51 offen lds
    s_add_u32 s50, s50, 128
    s_add_u32 s52, s52, 2048
    s_add_u32 s93, s93, 22528
    s_cmp_ge_u32 s93, 157696
    s_cselect_b32 s93, 0, s93
    s_waitcnt vmcnt(10)
    s_barrier
    s_add_u32 m0, s93, 6144
    s_nop 0
    buffer_load_dwordx4 v4, s[32:35], s50 offen lds
    s_add_u32 m0, s93, 7168
    s_nop 0
    buffer_load_dwordx4 v5, s[32:35], s50 offen lds
    s_add_u32 s51, s52, 328704
    s_add_u32 m0, s93, 19456
    s_nop 0
    buffer_load_dwordx4 v6, s[36:39], s51 offen lds
    s_add_u32 s51, s52, 393216
    s_add_u32 m0, s93, 20480
    s_nop 0
    buffer_load_dwordx4 v6, s[36:39], s51 offen lds
    s_add_u32 s51, s52, 394240
    s_add_u32 m0, s93, 21504
    s_nop 0
    buffer_load_dwordx4 v6, s[36:39], s51 offen lds
    s_add_u32 s50, s50, 128
    s_add_u32 s52, s52, 2048
    s_add_u32 s93, s93, 22528
    s_cmp_ge_u32 s93, 157696
    s_cselect_b32 s93, 0, s93
    s_add_u32 m0, s93, 6144
    s_nop 0
    buffer_load_dwordx4 v4, s[32:35], s50 offen lds
    s_add_u32 m0, s93, 7168
    s_nop 0
    buffer_load_dwordx4 v5, s[32:35], s50 offen lds
    s_add_u32 s51, s52, 328704
    s_add_u32 m0, s93, 19456
    s_nop 0
    buffer_load_dwordx4 v6, s[36:39], s51 offen lds
    s_add_u32 s51, s52, 393216
    s_add_u32 m0, s93, 20480
    s_nop 0
    buffer_load_dwordx4 v6, s[36:39], s51 offen lds
    s_add_u32 s51, s52, 394240
    s_add_u32 m0, s93, 21504
    s_nop 0
    buffer_load_dwordx4 v6, s[36:39], s51 offen lds
    s_add_u32 s50, s50, 128
    s_add_u32 s52, s52, 2048
    s_add_u32 s93, s93, 22528
    s_cmp_ge_u32 s93, 157696
    s_cselect_b32 s93, 0, s93
    s_waitcnt vmcnt(15)
    s_barrier
    s_add_u32 m0, s93, 6144
    s_nop 0
    buffer_load_dwordx4 v4, s[32:35], s50 offen lds
    s_add_u32 m0, s93, 7168
    s_nop 0
    buffer_load_dwordx4 v5, s[32:35], s50 offen lds
    s_add_u32 s51, s52, 328704
    s_add_u32 m0, s93, 19456
    s_nop 0
    buffer_load_dwordx4 v6, s[36:39], s51 offen lds
    s_add_u32 s51, s52, 393216
    s_add_u32 m0, s93, 20480
    s_nop 0
    buffer_load_dwordx4 v6, s[36:39], s51 offen lds
    s_add_u32 s51, s52, 394240
    s_add_u32 m0, s93, 21504
    s_nop 0
    buffer_load_dwordx4 v6, s[36:39], s51 offen lds
    s_add_u32 s50, s50, 128
    s_add_u32 s52, s52, 2048
    s_add_u32 s93, s93, 22528
    s_cmp_ge_u32 s93, 157696
    s_cselect_b32 s93, 0, s93
    s_add_u32 m0, s93, 6144
    s_nop 0
    buffer_load_dwordx4 v4, s[32:35], s50 offen lds
    s_add_u32 m0, s93, 7168
    s_nop 0
    buffer_load_dwordx4 v5, s[32:35], s50 offen lds
    s_add_u32 s51, s52, 328704
    s_add_u32 m0, s93, 19456
    s_nop 0
    buffer_load_dwordx4 v6, s[36:39], s51 offen lds
    s_add_u32 s51, s52, 393216
    s_add_u32 m0, s93, 20480
    s_nop 0
    buffer_load_dwordx4 v6, s[36:39], s51 offen lds
    s_add_u32 s51, s52, 394240
    s_add_u32 m0, s93, 21504
    s_nop 0
    buffer_load_dwordx4 v6, s[36:39], s51 offen lds
    s_add_u32 s50, s50, 128
    s_add_u32 s52, s52, 2048
    s_add_u32 s93, s93, 22528
    s_cmp_ge_u32 s93, 157696
    s_cselect_b32 s93, 0, s93
    s_waitcnt vmcnt(20)
    s_barrier
    s_add_u32 m0, s93, 6144
    s_nop 0
    buffer_load_dwordx4 v4, s[32:35], s50 offen lds
    s_add_u32 m0, s93, 7168
    s_nop 0
    buffer_load_dwordx4 v5, s[32:35], s50 offen lds
    s_add_u32 s51, s52, 328704
    s_add_u32 m0, s93, 19456
    s_nop 0
    buffer_load_dwordx4 v6, s[36:39], s51 offen lds
    s_add_u32 s51, s52, 393216
    s_add_u32 m0, s93, 20480
    s_nop 0
    buffer_load_dwordx4 v6, s[36:39], s51 offen lds
    s_add_u32 s51, s52, 394240
    s_add_u32 m0, s93, 21504
    s_nop 0
    buffer_load_dwordx4 v6, s[36:39], s51 offen lds
    s_add_u32 s50, s50, 128
    s_add_u32 s52, s52, 2048
    s_add_u32 s93, s93, 22528
    s_cmp_ge_u32 s93, 157696
    s_cselect_b32 s93, 0, s93
    s_add_u32 m0, s93, 6144
    s_nop 0
    buffer_load_dwordx4 v4, s[32:35], s50 offen lds
    s_add_u32 m0, s93, 7168
    s_nop 0
    buffer_load_dwordx4 v5, s[32:35], s50 offen lds
    s_add_u32 s51, s52, 328704
    s_add_u32 m0, s93, 19456
    s_nop 0
    buffer_load_dwordx4 v6, s[36:39], s51 offen lds
    s_add_u32 s51, s52, 393216
    s_add_u32 m0, s93, 20480
    s_nop 0
    buffer_load_dwordx4 v6, s[36:39], s51 offen lds
    s_add_u32 s51, s52, 394240
    s_add_u32 m0, s93, 21504
    s_nop 0
    buffer_load_dwordx4 v6, s[36:39], s51 offen lds
    s_add_u32 s50, s50, 128
    s_add_u32 s52, s52, 2048
    s_add_u32 s93, s93, 22528
    s_cmp_ge_u32 s93, 157696
    s_cselect_b32 s93, 0, s93
    s_movk_i32 s92, 23
ldl9:
    s_waitcnt vmcnt(25)
    s_barrier
    s_add_u32 m0, s93, 6144
    s_nop 0
    buffer_load_dwordx4 v4, s[32:35], s50 offen lds
    s_add_u32 m0, s93, 7168
    s_nop 0
    buffer_load_dwordx4 v5, s[32:35], s50 offen lds
    s_add_u32 s51, s52, 328704
    s_add_u32 m0, s93, 19456
    s_nop 0
    buffer_load_dwordx4 v6, s[36:39], s51 offen lds
    s_add_u32 s51, s52, 393216
    s_add_u32 m0, s93, 20480
    s_nop 0
    buffer_load_dwordx4 v6, s[36:39], s51 offen lds
    s_add_u32 s51, s52, 394240
    s_add_u32 m0, s93, 21504
    s_nop 0
    buffer_load_dwordx4 v6, s[36:39], s51 offen lds
    s_add_u32 s50, s50, 128
    s_add_u32 s52, s52, 2048
    s_add_u32 s93, s93, 22528
    s_cmp_ge_u32 s93, 157696
    s_cselect_b32 s93, 0, s93
    s_sub_u32 s92, s92, 1
    s_cmp_lg_u32 s92, 0
    s_cbranch_scc1 ldl9
    s_waitcnt vmcnt(25)
    s_barrier
    s_waitcnt vmcnt(20)
    s_barrier
    s_waitcnt vmcnt(15)
    s_barrier
    s_waitcnt vmcnt(10)
    s_barrier
    s_waitcnt vmcnt(5)
    s_barrier
    s_waitcnt vmcnt(0)
    s_barrier
    s_endpgm
k3_kernel_done:
    s_endpgm
.globl k4_kernel
.p2align 8
.type k4_kernel,@function
k4_kernel:
    s_cmp_ge_u32 s2, 224
    s_cbranch_scc1 k4_kernel_done
    s_load_dwordx16 s[16:31], s[0:1], 0
    v_lshrrev_b32 v1, 6, v0
    v_and_b32 v0, 63, v0
    v_readfirstlane_b32 s8, v1
    v_and_b32 v1, 15, v0
    v_lshrrev_b32 v2, 4, v0
    s_and_b32 s3, s2, 7
    s_lshr_b32 s4, s2, 3
    s_and_b32 s5, s3, 3
    s_lshl_b32 s5, s5, 3
    s_lshr_b32 s6, s3, 2
    s_lshl_b32 s6, s6, 2
    s_add_u32 s5, s5, s6
    s_and_b32 s6, s4, 3
    s_add_u32 s5, s5, s6
    s_lshr_b32 s6, s4, 2
    s_lshl_b32 s9, s6, 7
    s_cmp_ge_u32 s8, 4
    s_cbranch_scc1 k4_loader
    s_lshl_b32 s10, s5, 6
    s_lshl_b32 s11, s8, 4
    s_add_u32 s10, s10, s11

    v_add_u32 v4, s10, v1
    v_mul_u32_u24 v4, 896, v4
    v_lshl_add_u32 v4, v2, 3, v4
    v_add_u32 v4, s9, v4
    s_lshl_b32 s11, s8, 11
    v_lshl_add_u32 v5, v0, 4, s11
    v_lshrrev_b32 v20, 2, v1
    v_lshl_add_u32 v20, v2, 2, v20
    v_bfe_u32 v21, v20, 1, 2
    v_and_b32 v22, 3, v1
    v_lshlrev_b32 v22, 3, v22
    v_lshl_add_u32 v22, v20, 7, v22
    v_add_u32 v22, 8192, v22
    v_xor_b32 v20, 0, v21
    v_lshl_add_u32 v8, v20, 5, v22
    v_xor_b32 v20, 1, v21
    v_lshl_add_u32 v9, v20, 5, v22
    v_xor_b32 v20, 2, v21
    v_lshl_add_u32 v10, v20, 5, v22
    v_xor_b32 v20, 3, v21
    v_lshl_add_u32 v11, v20, 5, v22
    v_mov_b32 v64, 0
    v_mov_b32 v65, 0
    v_mov_b32 v66, 0
    v_mov_b32 v67, 0
    v_mov_b32 v68, 0
    v_mov_b32 v69, 0
    v_mov_b32 v70, 0
    v_mov_b32 v71, 0
    v_mov_b32 v72, 0
    v_mov_b32 v73, 0
    v_mov_b32 v74, 0
    v_mov_b32 v75, 0
    v_mov_b32 v76, 0
    v_mov_b32 v77, 0
    v_mov_b32 v78, 0
    v_mov_b32 v79, 0
    s_waitcnt lgkmcnt(0)
    s_mov_b32 s40, s26
    s_and_b32 s41, s27, 0xffff
    s_mov_b32 s42, 0x1c0000
    s_mov_b32 s43, 0x00020000
    v_mov_b32 v6, v5
    v_mov_b32 v12, v8
    v_mov_b32 v13, v9
    v_mov_b32 v14, v10
    v_mov_b32 v15, v11
    s_barrier
    ds_read_b128 v[24:27], v6 offset:0
    ds_read_b64_tr_b16 v[32:33], v12 offset:0
    ds_read_b64_tr_b16 v[34:35], v12 offset:2048
    ds_read_b64_tr_b16 v[36:37], v13 offset:0
    ds_read_b64_tr_b16 v[38:39], v13 offset:2048
    ds_read_b64_tr_b16 v[40:41], v14 offset:0
    ds_read_b64_tr_b16 v[42:43], v14 offset:2048
    ds_read_b64_tr_b16 v[44:45], v15 offset:0
    ds_read_b64_tr_b16 v[46:47], v15 offset:2048
    ds_read_b128 v[28:31], v6 offset:1024
    ds_read_b64_tr_b16 v[48:49], v12 offset:4096
    ds_read_b64_tr_b16 v[50:51], v12 offset:6144
    ds_read_b64_tr_b16 v[52:53], v13 offset:4096
    ds_read_b64_tr_b16 v[54:55], v13 offset:6144
    ds_read_b64_tr_b16 v[56:57], v14 offset:4096
    ds_read_b64_tr_b16 v[58:59], v14 offset:6144
    ds_read_b64_tr_b16 v[60:61], v15 offset:4096
    ds_read_b64_tr_b16 v[62:63], v15 offset:6144
    s_waitcnt lgkmcnt(9)
    v_mfma_f32_16x16x32_bf16 v[64:67], v[32:35], v[24:27], v[64:67]
    v_mfma_f32_16x16x32_bf16 v[68:71], v[36:39], v[24:27], v[68:71]
    v_mfma_f32_16x16x32_bf16 v[72:75], v[40:43], v[24:27], v[72:75]
    v_mfma_f32_16x16x32_bf16 v[76:79], v[44:47], v[24:27], v[76:79]
    s_waitcnt lgkmcnt(0)
    s_movk_i32 s91, 13
    s_mov_b32 s90, 0
cl10:
    s_add_u32 s90, s90, 16384
    s_cmp_ge_u32 s90, 163840
    s_cselect_b32 s90, 0, s90
    v_add_u32 v6, s90, v5
    v_add_u32 v12, s90, v8
    v_add_u32 v13, s90, v9
    v_add_u32 v14, s90, v10
    v_add_u32 v15, s90, v11
    s_barrier
    ds_read_b128 v[24:27], v6 offset:0
    ds_read_b64_tr_b16 v[32:33], v12 offset:0
    ds_read_b64_tr_b16 v[34:35], v12 offset:2048
    ds_read_b64_tr_b16 v[36:37], v13 offset:0
    ds_read_b64_tr_b16 v[38:39], v13 offset:2048
    ds_read_b64_tr_b16 v[40:41], v14 offset:0
    ds_read_b64_tr_b16 v[42:43], v14 offset:2048
    ds_read_b64_tr_b16 v[44:45], v15 offset:0
    ds_read_b64_tr_b16 v[46:47], v15 offset:2048
    v_mfma_f32_16x16x32_bf16 v[64:67], v[48:51], v[28:31], v[64:67]
    v_mfma_f32_16x16x32_bf16 v[68:71], v[52:55], v[28:31], v[68:71]
    v_mfma_f32_16x16x32_bf16 v[72:75], v[56:59], v[28:31], v[72:75]
    v_mfma_f32_16x16x32_bf16 v[76:79], v[60:63], v[28:31], v[76:79]
    ds_read_b128 v[28:31], v6 offset:1024
    ds_read_b64_tr_b16 v[48:49], v12 offset:4096
    ds_read_b64_tr_b16 v[50:51], v12 offset:6144
    ds_read_b64_tr_b16 v[52:53], v13 offset:4096
    ds_read_b64_tr_b16 v[54:55], v13 offset:6144
    ds_read_b64_tr_b16 v[56:57], v14 offset:4096
    ds_read_b64_tr_b16 v[58:59], v14 offset:6144
    ds_read_b64_tr_b16 v[60:61], v15 offset:4096
    ds_read_b64_tr_b16 v[62:63], v15 offset:6144
    s_waitcnt lgkmcnt(9)
    v_mfma_f32_16x16x32_bf16 v[64:67], v[32:35], v[24:27], v[64:67]
    v_mfma_f32_16x16x32_bf16 v[68:71], v[36:39], v[24:27], v[68:71]
    v_mfma_f32_16x16x32_bf16 v[72:75], v[40:43], v[24:27], v[72:75]
    v_mfma_f32_16x16x32_bf16 v[76:79], v[44:47], v[24:27], v[76:79]
    s_sub_u32 s91, s91, 1
    s_cmp_lg_u32 s91, 0
    s_waitcnt lgkmcnt(0)
    s_cbranch_scc1 cl10
    v_mfma_f32_16x16x32_bf16 v[64:67], v[48:51], v[28:31], v[64:67]
    v_mfma_f32_16x16x32_bf16 v[68:71], v[52:55], v[28:31], v[68:71]
    v_mfma_f32_16x16x32_bf16 v[72:75], v[56:59], v[28:31], v[72:75]
    v_mfma_f32_16x16x32_bf16 v[76:79], v[60:63], v[28:31], v[76:79]
    s_nop 7
    s_nop 7
    v_cvt_pk_bf16_f32 v24, v64, v65
    v_cvt_pk_bf16_f32 v25, v66, v67
    buffer_store_dwordx2 v[24:25], v4, s[40:43], 0 offen offset:0
    v_cvt_pk_bf16_f32 v26, v68, v69
    v_cvt_pk_bf16_f32 v27, v70, v71
    buffer_store_dwordx2 v[26:27], v4, s[40:43], 0 offen offset:32
    v_cvt_pk_bf16_f32 v28, v72, v73
    v_cvt_pk_bf16_f32 v29, v74, v75
    buffer_store_dwordx2 v[28:29], v4, s[40:43], 0 offen offset:64
    v_cvt_pk_bf16_f32 v30, v76, v77
    v_cvt_pk_bf16_f32 v31, v78, v79
    buffer_store_dwordx2 v[30:31], v4, s[40:43], 0 offen offset:96
    s_endpgm
k4_loader:
    s_sub_u32 s10, s8, 4
    s_lshl_b32 s11, s5, 2
    s_add_u32 s11, s11, s10
    s_mul_i32 s11, s11, 28672
    v_lshl_add_u32 v4, v0, 4, s11
    s_lshl_b32 s12, s10, 3
    v_lshrrev_b32 v6, 3, v0
    v_add_u32 v6, s12, v6
    v_bfe_u32 v7, v6, 1, 2
    v_bfe_u32 v8, v0, 1, 2
    v_xor_b32 v7, v7, v8
    v_and_b32 v8, 1, v0
    v_lshl_add_u32 v7, v7, 1, v8
    v_lshlrev_b32 v7, 4, v7
    v_bfe_u32 v8, v6, 2, 2
    v_lshlrev_b32 v8, 3, v8
    v_and_b32 v5, 3, v6
    v_add_u32 v8, v8, v5
    v_lshrrev_b32 v6, 4, v6
    v_lshl_add_u32 v8, v6, 2, v8
    v_mul_u32_u24 v8, 896, v8
    v_add3_u32 v5, v8, v7, s9
    s_lshl_b32 s48, s10, 11
    s_lshl_b32 s49, s10, 10
    s_waitcnt lgkmcnt(0)
    s_add_u32 s32, s30, 0xc00000
    s_addc_u32 s33, s31, 0
    s_and_b32 s33, s33, 0xffff
    s_mov_b32 s34, 0x380000
    s_mov_b32 s35, 0x00020000
    s_mov_b32 s36, s24
    s_and_b32 s37, s25, 0xffff
    s_mov_b32 s38, 0xc4000
    s_mov_b32 s39, 0x00020000
    s_mov_b32 s50, 0
    s_mov_b32 s51, 0
    s_mov_b32 s93, 0
    s_add_u32 s94, s93, s48
    s_add_u32 s95, s93, s49
    s_add_u32 m0, s94, 0
    s_nop 0
    buffer_load_dwordx4 v4, s[32:35], s50 offen lds
    s_add_u32 m0, s95, 8192
    s_nop 0
    buffer_load_dwordx4 v5, s[36:39], s51 offen lds
    s_add_u32 s50, s50, 1024
    s_add_u32 s51, s51, 28672
    s_add_u32 m0, s94, 1024
    s_nop 0
    buffer_load_dwordx4 v4, s[32:35], s50 offen lds
    s_add_u32 m0, s95, 12288
    s_nop 0
    buffer_load_dwordx4 v5, s[36:39], s51 offen lds
    s_add_u32 s50, s50, 1024
    s_add_u32 s51, s51, 28672
    s_add_u32 s93, s93, 16384
    s_cmp_ge_u32 s93, 163840
    s_cselect_b32 s93, 0, s93
    s_add_u32 s94, s93, s48
    s_add_u32 s95, s93, s49
    s_add_u32 m0, s94, 0
    s_nop 0
    buffer_load_dwordx4 v4, s[32:35], s50 offen lds
    s_add_u32 m0, s95, 8192
    s_nop 0
    buffer_load_dwordx4 v5, s[36:39], s51 offen lds
    s_add_u32 s50, s50, 1024
    s_add_u32 s51, s51, 28672
    s_add_u32 m0, s94, 1024
    s_nop 0
    buffer_load_dwordx4 v4, s[32:35], s50 offen lds
    s_add_u32 m0, s95, 12288
    s_nop 0
    buffer_load_dwordx4 v5, s[36:39], s51 offen lds
    s_add_u32 s50, s50, 1024
    s_add_u32 s51, s51, 28672
    s_add_u32 s93, s93, 16384
    s_cmp_ge_u32 s93, 163840
    s_cselect_b32 s93, 0, s93
    s_add_u32 s94, s93, s48
    s_add_u32 s95, s93, s49
    s_add_u32 m0, s94, 0
    s_nop 0
    buffer_load_dwordx4 v4, s[32:35], s50 offen lds
    s_add_u32 m0, s95, 8192
    s_nop 0
    buffer_load_dwordx4 v5, s[36:39], s51 offen lds
    s_add_u32 s50, s50, 1024
    s_add_u32 s51, s51, 28672
    s_add_u32 m0, s94, 1024
    s_nop 0
    buffer_load_dwordx4 v4, s[32:35], s50 offen lds
    s_add_u32 m0, s95, 12288
    s_nop 0
    buffer_load_dwordx4 v5, s[36:39], s51 offen lds
    s_add_u32 s50, s50, 1024
    s_add_u32 s51, s51, 28672
    s_add_u32 s93, s93, 16384
    s_cmp_ge_u32 s93, 163840
    s_cselect_b32 s93, 0, s93
    s_waitcnt vmcnt(8)
    s_barrier
    s_add_u32 s94, s93, s48
    s_add_u32 s95, s93, s49
    s_add_u32 m0, s94, 0
    s_nop 0
    buffer_load_dwordx4 v4, s[32:35], s50 offen lds
    s_add_u32 m0, s95, 8192
    s_nop 0
    buffer_load_dwordx4 v5, s[36:39], s51 offen lds
    s_add_u32 s50, s50, 1024
    s_add_u32 s51, s51, 28672
    s_add_u32 m0, s94, 1024
    s_nop 0
    buffer_load_dwordx4 v4, s[32:35], s50 offen lds
    s_add_u32 m0, s95, 12288
    s_nop 0
    buffer_load_dwordx4 v5, s[36:39], s51 offen lds
    s_add_u32 s50, s50, 1024
    s_add_u32 s51, s51, 28672
    s_add_u32 s93, s93, 16384
    s_cmp_ge_u32 s93, 163840
    s_cselect_b32 s93, 0, s93
    s_add_u32 s94, s93, s48
    s_add_u32 s95, s93, s49
    s_add_u32 m0, s94, 0
    s_nop 0
    buffer_load_dwordx4 v4, s[32:35], s50 offen lds
    s_add_u32 m0, s95, 8192
    s_nop 0
    buffer_load_dwordx4 v5, s[36:39], s51 offen lds
    s_add_u32 s50, s50, 1024
    s_add_u32 s51, s51, 28672
    s_add_u32 m0, s94, 1024
    s_nop 0
    buffer_load_dwordx4 v4, s[32:35], s50 offen lds
    s_add_u32 m0, s95, 12288
    s_nop 0
    buffer_load_dwordx4 v5, s[36:39], s51 offen lds
    s_add_u32 s50, s50, 1024
    s_add_u32 s51, s51, 28672
    s_add_u32 s93, s93, 16384
    s_cmp_ge_u32 s93, 163840
    s_cselect_b32 s93, 0, s93
    s_waitcnt vmcnt(12)
    s_barrier
    s_add_u32 s94, s93, s48
    s_add_u32 s95, s93, s49
    s_add_u32 m0, s94, 0
    s_nop 0
    buffer_load_dwordx4 v4, s[32:35], s50 offen lds
    s_add_u32 m0, s95, 8192
    s_nop 0
    buffer_load_dwordx4 v5, s[36:39], s51 offen lds
    s_add_u32 s50, s50, 1024
    s_add_u32 s51, s51, 28672
    s_add_u32 m0, s94, 1024
    s_nop 0
    buffer_load_dwordx4 v4, s[32:35], s50 offen lds
    s_add_u32 m0, s95, 12288
    s_nop 0
    buffer_load_dwordx4 v5, s[36:39], s51 offen lds
    s_add_u32 s50, s50, 1024
    s_add_u32 s51, s51, 28672
    s_add_u32 s93, s93, 16384
    s_cmp_ge_u32 s93, 163840
    s_cselect_b32 s93, 0, s93
    s_add_u32 s94, s93, s48
    s_add_u32 s95, s93, s49
    s_add_u32 m0, s94, 0
    s_nop 0
    buffer_load_dwordx4 v4, s[32:35], s50 offen lds
    s_add_u32 m0, s95, 8192
    s_nop 0
    buffer_load_dwordx4 v5, s[36:39], s51 offen lds
    s_add_u32 s50, s50, 1024
    s_add_u32 s51, s51, 28672
    s_add_u32 m0, s94, 1024
    s_nop 0
    buffer_load_dwordx4 v4, s[32:35], s50 offen lds
    s_add_u32 m0, s95, 12288
    s_nop 0
    buffer_load_dwordx4 v5, s[36:39], s51 offen lds
    s_add_u32 s50, s50, 1024
    s_add_u32 s51, s51, 28672
    s_add_u32 s93, s93, 16384
    s_cmp_ge_u32 s93, 163840
    s_cselect_b32 s93, 0, s93
    s_waitcnt vmcnt(16)
    s_barrier
    s_add_u32 s94, s93, s48
    s_add_u32 s95, s93, s49
    s_add_u32 m0, s94, 0
    s_nop 0
    buffer_load_dwordx4 v4, s[32:35], s50 offen lds
    s_add_u32 m0, s95, 8192
    s_nop 0
    buffer_load_dwordx4 v5, s[36:39], s51 offen lds
    s_add_u32 s50, s50, 1024
    s_add_u32 s51, s51, 28672
    s_add_u32 m0, s94, 1024
    s_nop 0
    buffer_load_dwordx4 v4, s[32:35], s50 offen lds
    s_add_u32 m0, s95, 12288
    s_nop 0
    buffer_load_dwordx4 v5, s[36:39], s51 offen lds
    s_add_u32 s50, s50, 1024
    s_add_u32 s51, s51, 28672
    s_add_u32 s93, s93, 16384
    s_cmp_ge_u32 s93, 163840
    s_cselect_b32 s93, 0, s93
    s_add_u32 s94, s93, s48
    s_add_u32 s95, s93, s49
    s_add_u32 m0, s94, 0
    s_nop 0
    buffer_load_dwordx4 v4, s[32:35], s50 offen lds
    s_add_u32 m0, s95, 8192
    s_nop 0
    buffer_load_dwordx4 v5, s[36:39], s51 offen lds
    s_add_u32 s50, s50, 1024
    s_add_u32 s51, s51, 28672
    s_add_u32 m0, s94, 1024
    s_nop 0
    buffer_load_dwordx4 v4, s[32:35], s50 offen lds
    s_add_u32 m0, s95, 12288
    s_nop 0
    buffer_load_dwordx4 v5, s[36:39], s51 offen lds
    s_add_u32 s50, s50, 1024
    s_add_u32 s51, s51, 28672
    s_add_u32 s93, s93, 16384
    s_cmp_ge_u32 s93, 163840
    s_cselect_b32 s93, 0, s93
    s_waitcnt vmcnt(20)
    s_barrier
    s_add_u32 s94, s93, s48
    s_add_u32 s95, s93, s49
    s_add_u32 m0, s94, 0
    s_nop 0
    buffer_load_dwordx4 v4, s[32:35], s50 offen lds
    s_add_u32 m0, s95, 8192
    s_nop 0
    buffer_load_dwordx4 v5, s[36:39], s51 offen lds
    s_add_u32 s50, s50, 1024
    s_add_u32 s51, s51, 28672
    s_add_u32 m0, s94, 1024
    s_nop 0
    buffer_load_dwordx4 v4, s[32:35], s50 offen lds
    s_add_u32 m0, s95, 12288
    s_nop 0
    buffer_load_dwordx4 v5, s[36:39], s51 offen lds
    s_add_u32 s50, s50, 1024
    s_add_u32 s51, s51, 28672
    s_add_u32 s93, s93, 16384
    s_cmp_ge_u32 s93, 163840
    s_cselect_b32 s93, 0, s93
    s_add_u32 s94, s93, s48
    s_add_u32 s95, s93, s49
    s_add_u32 m0, s94, 0
    s_nop 0
    buffer_load_dwordx4 v4, s[32:35], s50 offen lds
    s_add_u32 m0, s95, 8192
    s_nop 0
    buffer_load_dwordx4 v5, s[36:39], s51 offen lds
    s_add_u32 s50, s50, 1024
    s_add_u32 s51, s51, 28672
    s_add_u32 m0, s94, 1024
    s_nop 0
    buffer_load_dwordx4 v4, s[32:35], s50 offen lds
    s_add_u32 m0, s95, 12288
    s_nop 0
    buffer_load_dwordx4 v5, s[36:39], s51 offen lds
    s_add_u32 s50, s50, 1024
    s_add_u32 s51, s51, 28672
    s_add_u32 s93, s93, 16384
    s_cmp_ge_u32 s93, 163840
    s_cselect_b32 s93, 0, s93
    s_waitcnt vmcnt(24)
    s_barrier
    s_add_u32 s94, s93, s48
    s_add_u32 s95, s93, s49
    s_add_u32 m0, s94, 0
    s_nop 0
    buffer_load_dwordx4 v4, s[32:35], s50 offen lds
    s_add_u32 m0, s95, 8192
    s_nop 0
    buffer_load_dwordx4 v5, s[36:39], s51 offen lds
    s_add_u32 s50, s50, 1024
    s_add_u32 s51, s51, 28672
    s_add_u32 m0, s94, 1024
    s_nop 0
    buffer_load_dwordx4 v4, s[32:35], s50 offen lds
    s_add_u32 m0, s95, 12288
    s_nop 0
    buffer_load_dwordx4 v5, s[36:39], s51 offen lds
    s_add_u32 s50, s50, 1024
    s_add_u32 s51, s51, 28672
    s_add_u32 s93, s93, 16384
    s_cmp_ge_u32 s93, 163840
    s_cselect_b32 s93, 0, s93
    s_add_u32 s94, s93, s48
    s_add_u32 s95, s93, s49
    s_add_u32 m0, s94, 0
    s_nop 0
    buffer_load_dwordx4 v4, s[32:35], s50 offen lds
    s_add_u32 m0, s95, 8192
    s_nop 0
    buffer_load_dwordx4 v5, s[36:39], s51 offen lds
    s_add_u32 s50, s50, 1024
    s_add_u32 s51, s51, 28672
    s_add_u32 m0, s94, 1024
    s_nop 0
    buffer_load_dwordx4 v4, s[32:35], s50 offen lds
    s_add_u32 m0, s95, 12288
    s_nop 0
    buffer_load_dwordx4 v5, s[36:39], s51 offen lds
    s_add_u32 s50, s50, 1024
    s_add_u32 s51, s51, 28672
    s_add_u32 s93, s93, 16384
    s_cmp_ge_u32 s93, 163840
    s_cselect_b32 s93, 0, s93
    s_waitcnt vmcnt(28)
    s_barrier
    s_add_u32 s94, s93, s48
    s_add_u32 s95, s93, s49
    s_add_u32 m0, s94, 0
    s_nop 0
    buffer_load_dwordx4 v4, s[32:35], s50 offen lds
    s_add_u32 m0, s95, 8192
    s_nop 0
    buffer_load_dwordx4 v5, s[36:39], s51 offen lds
    s_add_u32 s50, s50, 1024
    s_add_u32 s51, s51, 28672
    s_add_u32 m0, s94, 1024
    s_nop 0
    buffer_load_dwordx4 v4, s[32:35], s50 offen lds
    s_add_u32 m0, s95, 12288
    s_nop 0
    buffer_load_dwordx4 v5, s[36:39], s51 offen lds
    s_add_u32 s50, s50, 1024
    s_add_u32 s51, s51, 28672
    s_add_u32 s93, s93, 16384
    s_cmp_ge_u32 s93, 163840
    s_cselect_b32 s93, 0, s93
    s_waitcnt vmcnt(28)
    s_barrier
    s_waitcnt vmcnt(24)
    s_barrier
    s_waitcnt vmcnt(20)
    s_barrier
    s_waitcnt vmcnt(16)
    s_barrier
    s_waitcnt vmcnt(12)
    s_barrier
    s_waitcnt vmcnt(8)
    s_barrier
    s_waitcnt vmcnt(4)
    s_barrier
    s_waitcnt vmcnt(0)
    s_barrier
    s_endpgm
k4_kernel_done:
    s_endpgm
.section .rodata,"a"
.p2align 6
.amdhsa_kernel k1_kernel
  .amdhsa_next_free_vgpr 112
  .amdhsa_next_free_sgpr 100
  .amdhsa_accum_offset 112
  .amdhsa_group_segment_fixed_size 0
  .amdhsa_kernarg_size 64
  .amdhsa_user_sgpr_count 2
  .amdhsa_user_sgpr_kernarg_segment_ptr 1
  .amdhsa_system_sgpr_workgroup_id_x 1
.end_amdhsa_kernel
.p2align 6
.amdhsa_kernel k3_kernel
  .amdhsa_next_free_vgpr 128
  .amdhsa_next_free_sgpr 100
  .amdhsa_accum_offset 128
  .amdhsa_group_segment_fixed_size 0
  .amdhsa_kernarg_size 64
  .amdhsa_user_sgpr_count 2
  .amdhsa_user_sgpr_kernarg_segment_ptr 1
  .amdhsa_system_sgpr_workgroup_id_x 1
.end_amdhsa_kernel
.p2align 6
.amdhsa_kernel k4_kernel
  .amdhsa_next_free_vgpr 80
  .amdhsa_next_free_sgpr 100
  .amdhsa_accum_offset 80
  .amdhsa_group_segment_fixed_size 0
  .amdhsa_kernarg_size 64
  .amdhsa_user_sgpr_count 2
  .amdhsa_user_sgpr_kernarg_segment_ptr 1
  .amdhsa_system_sgpr_workgroup_id_x 1
.end_amdhsa_kernel
```
